```python
import torch

def _softmax(x, axis=-1):
    return torch.softmax(x, dim=axis)
def _gelu(x):
    return torch.nn.functional.gelu(x, approximate="tanh")
def _silu(x):
    return torch.nn.functional.silu(x)
def _sigmoid(x):
    return torch.sigmoid(x)
def _layernorm(x, axis=-1, eps=1e-5):
    m = x.mean(dim=axis, keepdim=True)
    v = x.var(dim=axis, keepdim=True, unbiased=False)
    return (x - m) / torch.sqrt(v + eps)
def _scatter_add(tgt, idx, src, axis=0):
    return tgt.clone().index_add_(axis, idx, src)
def _segment_sum(src, seg, n):
    out = torch.zeros((n,) + src.shape[1:], dtype=src.dtype)
    return out.index_add_(0, seg, src)
def _pad(x, pw):
    flat = tuple(v for pair in reversed(pw) for v in pair)
    return torch.nn.functional.pad(x, flat)

kernel_name = 'sequential_preLN__ssm_conv_s4__dense_activation_squared_relu__prompt'

def setup_inputs():

    _w = (lambda a: (lambda t: t.to(torch.bfloat16) if t.is_floating_point() else t)(torch.as_tensor(a)))
    def _A_setup():
        B, L, D, N = 1, 2048, 512, 128
        A_re = -(lambda _x: torch.exp(torch.as_tensor(_x)))((lambda *s: torch.randn(*s, dtype=torch.bfloat16) * 3.2)(D, N))
        A_im = torch.pi * (lambda *s: torch.randn(*s, dtype=torch.bfloat16) * 0.05)(D, N)
        B_re = (lambda *s: torch.randn(*s, dtype=torch.bfloat16) * 0.1)(D, N)
        B_im = (lambda *s: torch.randn(*s, dtype=torch.bfloat16) * 0.1)(D, N)
        C_re = (lambda *s: torch.randn(*s, dtype=torch.bfloat16) * 0.1)(D, N)
        C_im = (lambda *s: torch.randn(*s, dtype=torch.bfloat16) * 0.1)(D, N)
        log_dt = (lambda *s: torch.randn(*s, dtype=torch.bfloat16) * 0.05)(D) * 0.5 - 4.0
        Dskip = (lambda *s: torch.randn(*s, dtype=torch.bfloat16) * 0.05)(D)
        return {
            "u": _w((lambda *s: torch.randn(*s, dtype=torch.bfloat16) * 0.05)(B, L, D)),
            "A_re": _w(A_re),
            "A_im": _w(A_im),
            "B_re": _w(B_re),
            "B_im": _w(B_im),
            "C_re": _w(C_re),
            "C_im": _w(C_im),
            "log_dt": _w(log_dt),
            "Dskip": _w(Dskip),
        }
    _A_in = _A_setup()

    def _B_setup():
        B, S, D, F = 1, 2048, 512, 1792
        return {
            "x": _w((lambda *s: torch.randn(*s, dtype=torch.bfloat16) * 0.05)(B, S, D)),
            "w1": _w((lambda *s: torch.randn(*s, dtype=torch.bfloat16) * 0.05)(D, F)),
            "b1": _w((lambda *s: torch.randn(*s, dtype=torch.bfloat16) * 0.2)(F)),
            "w2": _w((lambda *s: torch.randn(*s, dtype=torch.bfloat16) * 0.05)(F, D)),
            "b2": _w((lambda *s: torch.randn(*s, dtype=torch.bfloat16) * 1.6)(D)),
        }
    _B_in = _B_setup()

    return {
        "A_u": _A_in["u"],
        "A_A_re": _A_in["A_re"],
        "A_A_im": _A_in["A_im"],
        "A_B_re": _A_in["B_re"],
        "A_B_im": _A_in["B_im"],
        "A_C_re": _A_in["C_re"],
        "A_C_im": _A_in["C_im"],
        "A_log_dt": _A_in["log_dt"],
        "A_Dskip": _A_in["Dskip"],
        "B_x": _B_in["x"],
        "B_w1": _B_in["w1"],
        "B_b1": _B_in["b1"],
        "B_w2": _B_in["w2"],
        "B_b2": _B_in["b2"],
    }

def reference(A_u, A_A_re, A_A_im, A_B_re, A_B_im, A_C_re, A_C_im, A_log_dt, A_Dskip, B_x, B_w1, B_b1, B_w2, B_b2):
    def _A_ref(u, A_re, A_im, B_re, B_im, C_re, C_im, log_dt, Dskip):
        Bsz, L, D = u.shape
        dt = torch.exp(log_dt)[:, None]
        A = A_re + 1j * A_im
        Bc = B_re + 1j * B_im
        Cc = C_re + 1j * C_im
        logdA = dt * A
        dB = dt * Bc
        l = (lambda x, dt: x.to(dt))(torch.arange(L), A_re.dtype)
        P = torch.exp(logdA[:, :, None] * l[None, None, :])
        K = torch.einsum("dn,dnl,dn->dl", Cc, P, dB).real
        L2 = 2 * L
        Kp = _pad(K, ((0, 0), (0, L)))
        up = (lambda x, *d: x.permute(*d))(u, 0, 2, 1)
        up = _pad(up, ((0, 0), (0, 0), (0, L)))
        Kf = (lambda x, axes=(-2,-1): torch.fft.rfft2(x.float(), dim=axes))(Kp[:, None, :], axes=(-2, -1))
        Uf = (lambda x, axes=(-2,-1): torch.fft.rfft2(x.float(), dim=axes))(up[:, :, None, :], axes=(-2, -1))
        Yf = Uf * Kf[None, :, :, :]
        y = (lambda x, s, axes=(-2,-1): torch.fft.irfft2(x, s=s, dim=axes).to(torch.bfloat16))(Yf, (1, L2), axes=(-2, -1))[:, :, 0, :L]
        y = (lambda x, *d: x.permute(*d))(y, 0, 2, 1) + u * Dskip[None, None, :]
        return y

    def _B_ref(x, w1, b1, w2, b2):
        h = torch.einsum("bsd,df->bsf", x, w1) + b1
        zero = torch.zeros_like(h)
        r = torch.where(h > zero, h, zero)
        h = r * r
        out = torch.einsum("bsf,fd->bsd", h, w2) + b2
        return out

    x = A_u
    h = x + _A_ref(_layernorm(x, axis=-1), A_A_re, A_A_im, A_B_re, A_B_im, A_C_re, A_C_im, A_log_dt, A_Dskip)
    h2 = h + _B_ref(_layernorm(h, axis=-1), B_w1, B_b1, B_w2, B_b2)
    return h2
```

```asm
; @launch kernel=sequential_preLN__ssm_conv_s4__dense_activation_squared_relu__prompt_kernel grid=(256,1,1) block=(256,1,1) lds=163840
.amdgcn_target "amdgcn-amd-amdhsa--gfx950"
.text
.globl sequential_preLN__ssm_conv_s4__dense_activation_squared_relu__prompt_kernel
.p2align 8
.type sequential_preLN__ssm_conv_s4__dense_activation_squared_relu__prompt_kernel,@function
sequential_preLN__ssm_conv_s4__dense_activation_squared_relu__prompt_kernel:
    s_cmp_ge_u32 s2, 256
    s_cbranch_scc1 L_exit
    s_load_dwordx16 s[32:47], s[0:1], 0
    s_load_dwordx2 s[64:65], s[0:1], 128
    s_load_dwordx16 s[48:63], s[0:1], 64
    s_getpc_b64 s[4:5]
L_pc:
    s_lshr_b32 s31, s2, 3
    v_xor_b32 v2, s31, v0
    v_and_b32 v2, 3, v2
    v_cmp_eq_u32 vcc, 0, v2
    v_lshlrev_b32 v2, 7, v0
    v_min_u32 v2, L_end-L_pc-4, v2
    s_mov_b64 exec, vcc
    global_load_dword v254, v2, s[4:5]
    s_mov_b64 exec, -1
    v_lshrrev_b32 v2, 6, v0
    v_and_b32 v1, 63, v0
    v_readfirstlane_b32 s3, v2
    v_and_b32 v7, 3, v1
    v_lshrrev_b32 v9, 2, v1
    v_lshlrev_b32 v10, 13, v7
    v_lshl_add_u32 v10, v9, 2, v10
    s_and_b32 s30, s2, 7
    s_lshl_b32 s29, s30, 5
    s_add_u32 s29, s29, s31
    s_lshr_b32 s73, s29, 2
    s_and_b32 s74, s29, 3
    s_lshl_b32 s74, s74, 7
    s_lshl_b32 s75, s3, 5
    s_add_u32 s74, s74, s75
    s_lshl_b32 s75, s73, 15
    s_lshl_b32 s76, s74, 1
    s_add_u32 s75, s75, s76
    s_add_u32 s76, s75, 4096
    v_lshrrev_b32 v6, 5, v1
    v_and_b32 v11, 31, v1
    v_lshlrev_b32 v11, 4, v11
    v_lshl_add_u32 v11, v6, 10, v11
    s_lshl_b32 s77, s29, 13
    s_lshl_b32 s78, s3, 11
    s_add_u32 s77, s77, s78
    s_lshr_b32 s79, s3, 1
    s_and_b32 s80, s3, 1
    s_lshl_b32 s81, s29, 1
    s_add_u32 s81, s81, s79
    s_lshl_b32 s82, s81, 8
    s_lshl_b32 s83, s80, 7
    s_add_u32 s82, s82, s83
    v_lshl_add_u32 v12, v1, 1, s82
    s_lshl_b32 s83, s81, 1
    v_mov_b32_e64 v13, s83
    s_mov_b32 s14, 0x200000
    s_mov_b32 s15, 0x20000
    s_mov_b32 s10, 0xb90000
    s_mov_b32 s11, 0x20000
    s_mov_b32 s18, 0x1c0000
    s_mov_b32 s19, 0x20000
    s_mov_b32 s22, 0x1c0000
    s_mov_b32 s23, 0x20000
    v_lshlrev_b32 v3, 4, v1
    v_lshrrev_b32 v4, 4, v1
    v_and_b32_e64 v5, 15, v1
    v_bfe_u32 v8, v1, 2, 2
    v_mul_u32_u24 v14, 8704, v9
    v_lshl_add_u32 v14, v7, 4, v14
    s_mul_i32 s85, s74, 4352
    s_lshl_b32 s86, s73, 6
    s_add_u32 s85, s85, s86
    s_add_u32 s85, s85, 0x0
    s_add_u32 s86, s85, 4352
    v_mov_b32 v40, 0
    v_mov_b32 v41, 0
    v_mov_b32 v42, 0
    v_mov_b32 v43, 0
    v_lshrrev_b32 v2, 1, v5
    v_lshlrev_b32 v2, 6, v2
    v_lshl_add_u32 v36, v4, 4, v2
    v_and_b32 v15, 1, v5
    v_lshl_add_u32 v248, v15, 3, v36
    v_mul_u32_u24 v247, 4576, v15
    v_mul_u32_u24 v246, 4160, v7
    v_sub_u32 v27, v4, v8
    v_lshlrev_b32 v27, 4, v27
    v_mul_u32_u24 v201, 544, v5
    v_lshl_add_u32 v201, v4, 4, v201
    v_mul_u32_u24 v232, 4160, v8
    v_lshl_add_u32 v232, v7, 4, v232
    v_lshlrev_b32 v233, 2, v1
    v_add_u32 v247, v247, v36
    v_add_u32 v246, v246, v27
    s_waitcnt lgkmcnt(0)
    s_mov_b32 s12, s32
    s_nop 0
    s_and_b32 s13, s33, 0xffff
    buffer_load_dword v32, v10, s[12:15], s75 offen offset:0
    buffer_load_dword v33, v10, s[12:15], s75 offen offset:1024
    buffer_load_dword v34, v10, s[12:15], s75 offen offset:2048
    buffer_load_dword v35, v10, s[12:15], s75 offen offset:3072
    buffer_load_dword v36, v10, s[12:15], s76 offen offset:0
    buffer_load_dword v37, v10, s[12:15], s76 offen offset:1024
    buffer_load_dword v38, v10, s[12:15], s76 offen offset:2048
    buffer_load_dword v39, v10, s[12:15], s76 offen offset:3072
    buffer_load_dwordx4 v[16:19], v11, s[12:15], s77 offen
    buffer_load_dwordx4 v[20:23], v11, s[12:15], s77 offen offset:512
    global_load_ushort v24, v13, s[46:47]
    global_load_ushort v25, v12, s[34:35]
    global_load_ushort v26, v12, s[36:37]
    global_load_ushort v28, v12, s[38:39]
    global_load_ushort v29, v12, s[40:41]
    global_load_ushort v30, v12, s[42:43]
    global_load_ushort v31, v12, s[44:45]
    global_load_ushort v251, v13, s[48:49]
    s_add_u32 s4, s64, 0xb58000
    s_addc_u32 s5, s65, 0
    s_load_dword s6, s[4:5], 0
    s_mov_b32 s8, s64
    s_and_b32 s9, s65, 0xffff
    s_mov_b32 s16, s52
    s_and_b32 s17, s53, 0xffff
    s_mov_b32 s20, s56
    s_and_b32 s21, s57, 0xffff
    s_mov_b32 s73, 0x05040100
    s_mov_b32 s74, 0x07060302
    s_mov_b32 s75, 0x3f803f80
    s_mul_i32 s76, s79, 131072
    s_add_u32 s76, s76, 16640
    s_mul_i32 s77, s79, 131072
    s_mul_i32 s78, s80, 4576
    s_add_u32 s78, s78, s76
    v_add_u32 v2, s78, v3
    s_mul_i32 s78, s79, 131072
    s_add_u32 s78, s78, 25856
    s_sub_u32 s4, s78, 464
    v_add_u32 v15, s4, v3
    v_cmp_lt_u32 vcc, 28, v1
    s_nop 1
    v_cndmask_b32 v2, v2, v15, vcc
    ds_write_b128 v2, v[40:43]
    s_sub_u32 s78, s78, 64256
    s_mul_i32 s4, s79, 29376
    s_add_u32 s4, s4, 32768
    s_lshl_b32 s88, s80, 8
    s_add_u32 s88, s88, s4
    s_mul_i32 s5, s80, 8704
    s_add_u32 s5, s5, s4
    s_add_u32 s5, s5, 11968
    v_add_u32 v202, s5, v201
    v_add_u32 v201, s4, v201
    s_lshl_b32 s5, s80, 11
    s_add_u32 s5, s5, s77
    v_lshl_add_u32 v231, v1, 5, s5
    s_add_u32 s5, s77, 4096
    v_add_u32 v232, s5, v232
    ds_write_b128 v232, v[40:43]
    s_lshl_b32 s5, s80, 7
    v_lshl_add_u32 v15, v5, 3, s5
    v_cvt_f32_u32 v15, v15
    v_mov_b32 v52, 0x44000000
    v_mov_b32 v53, 0x43800000
    v_cmp_ne_u32 vcc, 0, v4
    v_mov_b32 v2, 0x00000000
    s_nop 0
    v_cndmask_b32 v52, v2, v52, vcc
    v_cndmask_b32 v53, 1.0, v53, vcc
    v_cmp_ne_u32 vcc, 1, v4
    v_mov_b32 v2, 0x40800000
    s_nop 0
    v_cndmask_b32 v52, v2, v52, vcc
    v_cndmask_b32 v53, 1.0, v53, vcc
    v_cmp_ne_u32 vcc, 2, v4
    v_mov_b32 v2, 0x43800000
    s_nop 0
    v_cndmask_b32 v52, v2, v52, vcc
    v_cndmask_b32 v53, 2.0, v53, vcc
    v_add_f32 v52, v52, v15
    v_max_f32 v2, 0x3f400000, v52
    v_lshrrev_b32 v2, 14, v2
    v_add_u32 v204, s78, v2
    v_add_f32 v52, v52, v53
    v_lshrrev_b32 v2, 14, v52
    v_add_u32 v205, s78, v2
    v_add_f32 v52, v52, v53
    v_lshrrev_b32 v2, 14, v52
    v_add_u32 v206, s78, v2
    v_add_f32 v52, v52, v53
    v_lshrrev_b32 v2, 14, v52
    v_add_u32 v207, s78, v2
    v_mov_b32 v52, 0x44808000
    v_mov_b32 v53, 0x43800000
    v_cmp_ne_u32 vcc, 0, v4
    v_mov_b32 v2, 0x44c00000
    s_nop 0
    v_cndmask_b32 v52, v2, v52, vcc
    v_cmp_ne_u32 vcc, 1, v4
    v_mov_b32 v2, 0x44010000
    s_nop 0
    v_cndmask_b32 v52, v2, v52, vcc
    v_add_f32 v52, v52, v15
    v_lshrrev_b32 v2, 14, v52
    v_add_u32 v208, s78, v2
    v_add_f32 v52, v52, v53
    v_lshrrev_b32 v2, 14, v52
    v_add_u32 v209, s78, v2
    v_add_f32 v52, v52, v53
    v_lshrrev_b32 v2, 14, v52
    v_add_u32 v210, s78, v2
    v_add_f32 v52, v52, v53
    v_lshrrev_b32 v2, 14, v52
    v_add_u32 v211, s78, v2
    s_lshl_b32 s5, s80, 10
    s_sub_u32 s5, 2047, s5
    v_sub_u32 v52, s5, v3
    v_cvt_f32_i32 v52, v52
    v_add_f32 v53, -1.0, v52
    v_mov_b32 v15, 0x3f400000
    v_cvt_pk_bf16_f32 v2, v52, v53
    v_pk_add_f32 v[52:53], v[52:53], -2.0 op_sel_hi:[1,0]
    v_mad_u32_u16 v212, v2, 4, s78
    v_mad_u32_u16 v213, v2, 4, s78 op_sel:[1,0,0,0]
    v_cvt_pk_bf16_f32 v2, v52, v53
    v_pk_add_f32 v[52:53], v[52:53], -2.0 op_sel_hi:[1,0]
    v_mad_u32_u16 v214, v2, 4, s78
    v_mad_u32_u16 v215, v2, 4, s78 op_sel:[1,0,0,0]
    v_cvt_pk_bf16_f32 v2, v52, v53
    v_pk_add_f32 v[52:53], v[52:53], -2.0 op_sel_hi:[1,0]
    v_mad_u32_u16 v216, v2, 4, s78
    v_mad_u32_u16 v217, v2, 4, s78 op_sel:[1,0,0,0]
    v_cvt_pk_bf16_f32 v2, v52, v53
    v_pk_add_f32 v[52:53], v[52:53], -2.0 op_sel_hi:[1,0]
    v_mad_u32_u16 v218, v2, 4, s78
    v_mad_u32_u16 v219, v2, 4, s78 op_sel:[1,0,0,0]
    v_cvt_pk_bf16_f32 v2, v52, v53
    v_pk_add_f32 v[52:53], v[52:53], -2.0 op_sel_hi:[1,0]
    v_mad_u32_u16 v220, v2, 4, s78
    v_mad_u32_u16 v221, v2, 4, s78 op_sel:[1,0,0,0]
    v_cvt_pk_bf16_f32 v2, v52, v53
    v_pk_add_f32 v[52:53], v[52:53], -2.0 op_sel_hi:[1,0]
    v_mad_u32_u16 v222, v2, 4, s78
    v_mad_u32_u16 v223, v2, 4, s78 op_sel:[1,0,0,0]
    v_cvt_pk_bf16_f32 v2, v52, v53
    v_pk_add_f32 v[52:53], v[52:53], -2.0 op_sel_hi:[1,0]
    v_mad_u32_u16 v224, v2, 4, s78
    v_mad_u32_u16 v225, v2, 4, s78 op_sel:[1,0,0,0]
    v_fmamk_f32 v54, v52, 0x3e000000, v15
    v_fmamk_f32 v55, v53, 0x3e000000, v15
    v_max_f32 v54, v54, v52
    v_max_f32 v55, v55, v53
    v_cvt_pk_bf16_f32 v2, v54, v55
    v_pk_add_f32 v[52:53], v[52:53], -2.0 op_sel_hi:[1,0]
    v_mad_u32_u16 v226, v2, 4, s78
    v_mad_u32_u16 v227, v2, 4, s78 op_sel:[1,0,0,0]
    v_fmamk_f32 v54, v52, 0x3e000000, v15
    v_fmamk_f32 v55, v53, 0x3e000000, v15
    v_max_f32 v54, v54, v52
    v_max_f32 v55, v55, v53
    v_cvt_pk_bf16_f32 v2, v54, v55
    v_pk_add_f32 v[52:53], v[52:53], -2.0 op_sel_hi:[1,0]
    v_mad_u32_u16 v228, v2, 4, s78
    v_mad_u32_u16 v229, v2, 4, s78 op_sel:[1,0,0,0]
    v_fmamk_f32 v54, v52, 0x3e000000, v15
    v_fmamk_f32 v55, v53, 0x3e000000, v15
    v_max_f32 v54, v54, v52
    v_max_f32 v55, v55, v53
    v_cvt_pk_bf16_f32 v2, v54, v55
    v_mad_u32_u16 v230, v2, 4, s78
    s_waitcnt vmcnt(10)
    s_nop 0
    v_perm_b32 v44, v33, v32, s73
    v_perm_b32 v45, v35, v34, s73
    v_perm_b32 v46, v37, v36, s73
    v_perm_b32 v47, v39, v38, s73
    buffer_store_dwordx4 v[44:47], v14, s[8:11], s85 offen sc1
    v_perm_b32 v48, v33, v32, s74
    v_perm_b32 v49, v35, v34, s74
    v_perm_b32 v50, v37, v36, s74
    v_perm_b32 v51, v39, v38, s74
    buffer_store_dwordx4 v[48:51], v14, s[8:11], s86 offen sc1
    s_lshl_b32 s5, s2, 2
    s_add_u32 s5, s5, s3
    s_mul_i32 s5, s5, 1792
    v_lshlrev_b32 v2, 7, v1
    s_mov_b64 exec, 0x3fff
    buffer_load_dword v254, v2, s[20:23], s5 offen
    buffer_load_dword v253, v2, s[16:19], s5 offen
    s_mov_b64 exec, -1
    v_mov_b32 v52, 0
    v_mov_b32 v53, 0
    v_mov_b32 v54, 0
    v_mov_b32 v55, 0
    s_waitcnt vmcnt(12)
    s_nop 0
    v_dot2_f32_bf16 v52, v16, s75, v52
    v_dot2_f32_bf16 v54, v16, v16, v54
    v_dot2_f32_bf16 v53, v17, s75, v53
    v_dot2_f32_bf16 v55, v17, v17, v55
    v_dot2_f32_bf16 v52, v18, s75, v52
    v_dot2_f32_bf16 v54, v18, v18, v54
    v_dot2_f32_bf16 v53, v19, s75, v53
    v_dot2_f32_bf16 v55, v19, v19, v55
    v_dot2_f32_bf16 v52, v20, s75, v52
    v_dot2_f32_bf16 v54, v20, v20, v54
    v_dot2_f32_bf16 v53, v21, s75, v53
    v_dot2_f32_bf16 v55, v21, v21, v55
    v_dot2_f32_bf16 v52, v22, s75, v52
    v_dot2_f32_bf16 v54, v22, v22, v54
    v_dot2_f32_bf16 v53, v23, s75, v53
    v_dot2_f32_bf16 v55, v23, v23, v55
    s_nop 1
    v_add_f32 v52, v52, v53
    v_add_f32 v54, v54, v55
    s_nop 0
    v_add_f32_dpp v52, v52, v52 row_ror:8 row_mask:0xf bank_mask:0xf
    v_add_f32_dpp v54, v54, v54 row_ror:8 row_mask:0xf bank_mask:0xf
    s_nop 0
    v_add_f32_dpp v52, v52, v52 row_ror:4 row_mask:0xf bank_mask:0xf
    v_add_f32_dpp v54, v54, v54 row_ror:4 row_mask:0xf bank_mask:0xf
    s_nop 0
    v_add_f32_dpp v52, v52, v52 row_ror:2 row_mask:0xf bank_mask:0xf
    v_add_f32_dpp v54, v54, v54 row_ror:2 row_mask:0xf bank_mask:0xf
    s_nop 0
    v_add_f32_dpp v52, v52, v52 row_ror:1 row_mask:0xf bank_mask:0xf
    v_add_f32_dpp v54, v54, v54 row_ror:1 row_mask:0xf bank_mask:0xf
    v_mov_b32 v53, v52
    v_mov_b32 v55, v54
    s_lshl_b32 s91, s29, 6
    s_lshl_b32 s5, s3, 4
    s_add_u32 s91, s91, s5
    s_add_u32 s91, s91, 0xb40000
    v_permlane16_swap_b32 v52, v53
    v_permlane16_swap_b32 v54, v55
    v_add_f32 v52, v52, v53
    v_add_f32 v54, v54, v55
    v_mul_f32 v52, 0x3b000000, v52
    v_mul_f32 v54, 0x3b000000, v54
    v_fma_f32 v54, -v52, v52, v54
    v_max_f32 v54, 0, v54
    v_cvt_pk_bf16_f32 v53, v52, v54
    v_lshlrev_b32 v56, 16, v53
    v_and_b32 v53, 0xffff0000, v53
    v_add_f32 v53, 0x3727c5ac, v53
    v_cvt_pk_bf16_f32 v53, v53, v53
    v_and_b32 v53, 0xffff0000, v53
    v_sqrt_f32 v53, v53
    s_nop 0
    v_cvt_pk_bf16_f32 v53, v53, v53
    v_and_b32 v53, 0xffff0000, v53
    v_rcp_f32 v45, v53
    s_waitcnt lgkmcnt(0)
    s_add_u32 s28, s6, 1
    s_mul_i32 s28, s28, 0x9E3779B1
    v_readlane_b32 s92, v56, 32
    v_readlane_b32 s93, v45, 32
    v_lshrrev_b32 v44, 16, v56
    v_mov_b32 v47, s28
    v_or_b32 v44, s92, v44
    v_mov_b32 v46, s93
    s_mov_b32 s4, 0x3fb8aa3b
    s_waitcnt vmcnt(9)
    v_lshlrev_b32 v24, 16, v24
    v_lshlrev_b32 v25, 16, v25
    v_lshlrev_b32 v26, 16, v26
    v_mul_f32 v16, s4, v24
    v_fma_f32 v17, v24, s4, -v16
    v_fmac_f32 v17, 0x32a57060, v24
    v_exp_f32_e64 v16, v16
    v_mul_f32 v17, 0x3f317218, v17
    v_fma_f32 v16, v16, v17, v16
    v_cvt_pk_bf16_f32 v16, v16, v16
    v_and_b32 v16, 0xffff0000, v16
    v_mul_f32 v25, v16, v25
    v_mul_f32 v26, v16, v26
    v_mul_f32 v25, s4, v25
    v_mul_f32 v26, 0.15915494, v26
    v_mul_f32 v18, 0x41000000, v25
    v_mul_f32 v19, 0x41000000, v26
    v_exp_f32 v18, v18
    v_fract_f32 v19, v19
    v_cos_f32 v66, v19
    v_sin_f32 v67, v19
    s_nop 0
    v_pk_mul_f32 v[66:67], v[66:67], v[18:19] op_sel_hi:[1,0]
    s_mov_b32 m0, s88
    s_mov_b32 s94, 3
    s_nop 0
    v_mov_b32 v17, 0x00003f80
    ds_write_addtid_b32 v17 offset:11968
    v_pk_mul_f32 v[68:69], v[66:67], v[66:67] op_sel_hi:[0,1]
    v_pk_fma_f32 v[68:69], v[66:67], v[66:67], v[68:69] op_sel:[1,1,0] op_sel_hi:[1,0,1] neg_lo:[1,0,0]
    v_cvt_pk_bf16_f32 v20, v66, v67
    v_pk_mul_f32 v[70:71], v[68:69], v[66:67] op_sel_hi:[0,1]
    v_pk_fma_f32 v[70:71], v[68:69], v[66:67], v[70:71] op_sel:[1,1,0] op_sel_hi:[1,0,1] neg_lo:[1,0,0]
    v_cvt_pk_bf16_f32 v21, v68, v69
    ds_write_addtid_b32 v20 offset:12512
    ds_write_addtid_b32 v21 offset:13056
    v_pk_mul_f32 v[72:73], v[68:69], v[68:69] op_sel_hi:[0,1]
    v_pk_fma_f32 v[72:73], v[68:69], v[68:69], v[72:73] op_sel:[1,1,0] op_sel_hi:[1,0,1] neg_lo:[1,0,0]
    v_cvt_pk_bf16_f32 v22, v70, v71
    v_pk_mul_f32 v[74:75], v[72:73], v[66:67] op_sel_hi:[0,1]
    v_pk_fma_f32 v[74:75], v[72:73], v[66:67], v[74:75] op_sel:[1,1,0] op_sel_hi:[1,0,1] neg_lo:[1,0,0]
    v_cvt_pk_bf16_f32 v23, v72, v73
    ds_write_addtid_b32 v22 offset:13600
    ds_write_addtid_b32 v23 offset:14144
    v_pk_mul_f32 v[76:77], v[72:73], v[68:69] op_sel_hi:[0,1]
    v_pk_fma_f32 v[76:77], v[72:73], v[68:69], v[76:77] op_sel:[1,1,0] op_sel_hi:[1,0,1] neg_lo:[1,0,0]
    v_cvt_pk_bf16_f32 v20, v74, v75
    v_pk_mul_f32 v[78:79], v[72:73], v[70:71] op_sel_hi:[0,1]
    v_pk_fma_f32 v[78:79], v[72:73], v[70:71], v[78:79] op_sel:[1,1,0] op_sel_hi:[1,0,1] neg_lo:[1,0,0]
    v_cvt_pk_bf16_f32 v21, v76, v77
    ds_write_addtid_b32 v20 offset:14688
    ds_write_addtid_b32 v21 offset:15232
    v_pk_mul_f32 v[80:81], v[72:73], v[72:73] op_sel_hi:[0,1]
    v_pk_fma_f32 v[80:81], v[72:73], v[72:73], v[80:81] op_sel:[1,1,0] op_sel_hi:[1,0,1] neg_lo:[1,0,0]
    v_cvt_pk_bf16_f32 v22, v78, v79
    v_pk_mul_f32 v[82:83], v[80:81], v[66:67] op_sel_hi:[0,1]
    v_pk_fma_f32 v[82:83], v[80:81], v[66:67], v[82:83] op_sel:[1,1,0] op_sel_hi:[1,0,1] neg_lo:[1,0,0]
    v_cvt_pk_bf16_f32 v23, v80, v81
    ds_write_addtid_b32 v22 offset:15776
    ds_write_addtid_b32 v23 offset:16320
    v_pk_mul_f32 v[84:85], v[80:81], v[68:69] op_sel_hi:[0,1]
    v_pk_fma_f32 v[84:85], v[80:81], v[68:69], v[84:85] op_sel:[1,1,0] op_sel_hi:[1,0,1] neg_lo:[1,0,0]
    v_cvt_pk_bf16_f32 v20, v82, v83
    v_pk_mul_f32 v[86:87], v[80:81], v[70:71] op_sel_hi:[0,1]
    v_pk_fma_f32 v[86:87], v[80:81], v[70:71], v[86:87] op_sel:[1,1,0] op_sel_hi:[1,0,1] neg_lo:[1,0,0]
    v_cvt_pk_bf16_f32 v21, v84, v85
    ds_write_addtid_b32 v20 offset:16864
    ds_write_addtid_b32 v21 offset:17408
    v_pk_mul_f32 v[88:89], v[80:81], v[72:73] op_sel_hi:[0,1]
    v_pk_fma_f32 v[88:89], v[80:81], v[72:73], v[88:89] op_sel:[1,1,0] op_sel_hi:[1,0,1] neg_lo:[1,0,0]
    v_cvt_pk_bf16_f32 v22, v86, v87
    v_pk_mul_f32 v[90:91], v[80:81], v[74:75] op_sel_hi:[0,1]
    v_pk_fma_f32 v[90:91], v[80:81], v[74:75], v[90:91] op_sel:[1,1,0] op_sel_hi:[1,0,1] neg_lo:[1,0,0]
    v_cvt_pk_bf16_f32 v23, v88, v89
    ds_write_addtid_b32 v22 offset:17952
    ds_write_addtid_b32 v23 offset:18496
    v_pk_mul_f32 v[92:93], v[80:81], v[76:77] op_sel_hi:[0,1]
    v_pk_fma_f32 v[92:93], v[80:81], v[76:77], v[92:93] op_sel:[1,1,0] op_sel_hi:[1,0,1] neg_lo:[1,0,0]
    v_cvt_pk_bf16_f32 v20, v90, v91
    v_pk_mul_f32 v[94:95], v[80:81], v[78:79] op_sel_hi:[0,1]
    v_pk_fma_f32 v[94:95], v[80:81], v[78:79], v[94:95] op_sel:[1,1,0] op_sel_hi:[1,0,1] neg_lo:[1,0,0]
    v_cvt_pk_bf16_f32 v21, v92, v93
    ds_write_addtid_b32 v20 offset:19040
    ds_write_addtid_b32 v21 offset:19584
    v_pk_mul_f32 v[96:97], v[80:81], v[80:81] op_sel_hi:[0,1]
    v_pk_fma_f32 v[96:97], v[80:81], v[80:81], v[96:97] op_sel:[1,1,0] op_sel_hi:[1,0,1] neg_lo:[1,0,0]
    v_cvt_pk_bf16_f32 v22, v94, v95
    ds_write_addtid_b32 v22 offset:20128
    s_waitcnt vmcnt(15)
    s_getreg_b32 s93, hwreg(HW_REG_IB_STS, 0, 4)
    s_cmp_lt_u32 s93, s94
    s_cbranch_scc0 L_np0
    s_mov_b64 exec, 1
    buffer_store_dwordx4 v[44:47], v3, s[8:11], s91 offen sc1
    s_mov_b64 exec, -1
    s_mov_b32 s94, 0
L_np0:
    s_nop 0
    v_pk_mul_f32 v[58:59], v[96:97], v[66:67] op_sel_hi:[0,1]
    v_pk_fma_f32 v[58:59], v[96:97], v[66:67], v[58:59] op_sel:[1,1,0] op_sel_hi:[1,0,1] neg_lo:[1,0,0]
    v_cvt_pk_bf16_f32 v23, v96, v97
    v_pk_mul_f32 v[60:61], v[96:97], v[68:69] op_sel_hi:[0,1]
    v_pk_fma_f32 v[60:61], v[96:97], v[68:69], v[60:61] op_sel:[1,1,0] op_sel_hi:[1,0,1] neg_lo:[1,0,0]
    v_cvt_pk_bf16_f32 v20, v58, v59
    ds_write_addtid_b32 v23 offset:20672
    ds_write_addtid_b32 v20 offset:21216
    v_pk_mul_f32 v[62:63], v[96:97], v[70:71] op_sel_hi:[0,1]
    v_pk_fma_f32 v[62:63], v[96:97], v[70:71], v[62:63] op_sel:[1,1,0] op_sel_hi:[1,0,1] neg_lo:[1,0,0]
    v_cvt_pk_bf16_f32 v21, v60, v61
    v_pk_mul_f32 v[56:57], v[96:97], v[72:73] op_sel_hi:[0,1]
    v_pk_fma_f32 v[56:57], v[96:97], v[72:73], v[56:57] op_sel:[1,1,0] op_sel_hi:[1,0,1] neg_lo:[1,0,0]
    v_cvt_pk_bf16_f32 v22, v62, v63
    ds_write_addtid_b32 v21 offset:21760
    ds_write_addtid_b32 v22 offset:22304
    v_pk_mul_f32 v[58:59], v[96:97], v[74:75] op_sel_hi:[0,1]
    v_pk_fma_f32 v[58:59], v[96:97], v[74:75], v[58:59] op_sel:[1,1,0] op_sel_hi:[1,0,1] neg_lo:[1,0,0]
    v_cvt_pk_bf16_f32 v23, v56, v57
    v_pk_mul_f32 v[60:61], v[96:97], v[76:77] op_sel_hi:[0,1]
    v_pk_fma_f32 v[60:61], v[96:97], v[76:77], v[60:61] op_sel:[1,1,0] op_sel_hi:[1,0,1] neg_lo:[1,0,0]
    v_cvt_pk_bf16_f32 v20, v58, v59
    ds_write_addtid_b32 v23 offset:22848
    ds_write_addtid_b32 v20 offset:23392
    v_pk_mul_f32 v[62:63], v[96:97], v[78:79] op_sel_hi:[0,1]
    v_pk_fma_f32 v[62:63], v[96:97], v[78:79], v[62:63] op_sel:[1,1,0] op_sel_hi:[1,0,1] neg_lo:[1,0,0]
    v_cvt_pk_bf16_f32 v21, v60, v61
    v_pk_mul_f32 v[56:57], v[96:97], v[80:81] op_sel_hi:[0,1]
    v_pk_fma_f32 v[56:57], v[96:97], v[80:81], v[56:57] op_sel:[1,1,0] op_sel_hi:[1,0,1] neg_lo:[1,0,0]
    v_cvt_pk_bf16_f32 v22, v62, v63
    ds_write_addtid_b32 v21 offset:23936
    ds_write_addtid_b32 v22 offset:24480
    v_pk_mul_f32 v[58:59], v[96:97], v[82:83] op_sel_hi:[0,1]
    v_pk_fma_f32 v[58:59], v[96:97], v[82:83], v[58:59] op_sel:[1,1,0] op_sel_hi:[1,0,1] neg_lo:[1,0,0]
    v_cvt_pk_bf16_f32 v23, v56, v57
    v_pk_mul_f32 v[60:61], v[96:97], v[84:85] op_sel_hi:[0,1]
    v_pk_fma_f32 v[60:61], v[96:97], v[84:85], v[60:61] op_sel:[1,1,0] op_sel_hi:[1,0,1] neg_lo:[1,0,0]
    v_cvt_pk_bf16_f32 v20, v58, v59
    ds_write_addtid_b32 v23 offset:25024
    ds_write_addtid_b32 v20 offset:25568
    s_getreg_b32 s93, hwreg(HW_REG_IB_STS, 0, 4)
    s_cmp_lt_u32 s93, s94
    s_cbranch_scc0 L_np1
    s_mov_b64 exec, 1
    buffer_store_dwordx4 v[44:47], v3, s[8:11], s91 offen sc1
    s_mov_b64 exec, -1
    s_mov_b32 s94, 0
L_np1:
    v_pk_mul_f32 v[62:63], v[96:97], v[86:87] op_sel_hi:[0,1]
    v_pk_fma_f32 v[62:63], v[96:97], v[86:87], v[62:63] op_sel:[1,1,0] op_sel_hi:[1,0,1] neg_lo:[1,0,0]
    v_cvt_pk_bf16_f32 v21, v60, v61
    v_pk_mul_f32 v[56:57], v[96:97], v[88:89] op_sel_hi:[0,1]
    v_pk_fma_f32 v[56:57], v[96:97], v[88:89], v[56:57] op_sel:[1,1,0] op_sel_hi:[1,0,1] neg_lo:[1,0,0]
    v_cvt_pk_bf16_f32 v22, v62, v63
    ds_write_addtid_b32 v21 offset:26112
    ds_write_addtid_b32 v22 offset:26656
    v_pk_mul_f32 v[58:59], v[96:97], v[90:91] op_sel_hi:[0,1]
    v_pk_fma_f32 v[58:59], v[96:97], v[90:91], v[58:59] op_sel:[1,1,0] op_sel_hi:[1,0,1] neg_lo:[1,0,0]
    v_cvt_pk_bf16_f32 v23, v56, v57
    v_pk_mul_f32 v[60:61], v[96:97], v[92:93] op_sel_hi:[0,1]
    v_pk_fma_f32 v[60:61], v[96:97], v[92:93], v[60:61] op_sel:[1,1,0] op_sel_hi:[1,0,1] neg_lo:[1,0,0]
    v_cvt_pk_bf16_f32 v20, v58, v59
    ds_write_addtid_b32 v23 offset:27200
    ds_write_addtid_b32 v20 offset:27744
    v_pk_mul_f32 v[62:63], v[96:97], v[94:95] op_sel_hi:[0,1]
    v_pk_fma_f32 v[62:63], v[96:97], v[94:95], v[62:63] op_sel:[1,1,0] op_sel_hi:[1,0,1] neg_lo:[1,0,0]
    v_cvt_pk_bf16_f32 v21, v60, v61
    v_cvt_pk_bf16_f32 v22, v62, v63
    ds_write_addtid_b32 v21 offset:28288
    ds_write_addtid_b32 v22 offset:28832
    v_mul_f32 v18, 0x3f800000, v25
    v_mul_f32 v19, 0x3f800000, v26
    v_exp_f32 v18, v18
    v_fract_f32 v19, v19
    v_cos_f32 v64, v19
    v_sin_f32 v65, v19
    s_nop 0
    v_pk_mul_f32 v[64:65], v[64:65], v[18:19] op_sel_hi:[1,0]
    v_mul_f32 v18, 0x43800000, v25
    v_mul_f32 v19, 0x43800000, v26
    v_exp_f32 v18, v18
    v_fract_f32 v19, v19
    v_cos_f32 v66, v19
    v_sin_f32 v67, v19
    s_nop 0
    v_pk_mul_f32 v[66:67], v[66:67], v[18:19] op_sel_hi:[1,0]
    v_mul_f32 v18, 0x44800000, v25
    v_mul_f32 v19, 0x44800000, v26
    v_exp_f32 v18, v18
    v_fract_f32 v19, v19
    v_cos_f32 v68, v19
    v_sin_f32 v69, v19
    s_nop 0
    v_pk_mul_f32 v[68:69], v[68:69], v[18:19] op_sel_hi:[1,0]
    s_getreg_b32 s93, hwreg(HW_REG_IB_STS, 0, 4)
    s_cmp_lt_u32 s93, s94
    s_cbranch_scc0 L_np2
    s_mov_b64 exec, 1
    buffer_store_dwordx4 v[44:47], v3, s[8:11], s91 offen sc1
    s_mov_b64 exec, -1
    s_mov_b32 s94, 0
L_np2:
    s_waitcnt vmcnt(4)
    v_lshlrev_b32 v28, 16, v28
    v_lshlrev_b32 v29, 16, v29
    v_lshlrev_b32 v30, 16, v30
    v_lshlrev_b32 v31, 16, v31
    v_mul_f32 v28, v16, v28
    v_mul_f32 v29, v16, v29
    v_pk_mul_f32 v[70:71], v[64:65], v[64:65] op_sel_hi:[0,1]
    v_pk_fma_f32 v[70:71], v[64:65], v[64:65], v[70:71] op_sel:[1,1,0] op_sel_hi:[1,0,1] neg_lo:[1,0,0]
    v_pk_mul_f32 v[76:77], v[30:31], v[28:29] op_sel_hi:[0,1]
    v_pk_fma_f32 v[76:77], v[30:31], v[28:29], v[76:77] op_sel:[1,1,0] op_sel_hi:[1,0,1] neg_lo:[1,0,0]
    v_pk_mul_f32 v[74:75], v[66:67], v[66:67] op_sel_hi:[0,1]
    v_pk_fma_f32 v[74:75], v[66:67], v[66:67], v[74:75] op_sel:[1,1,0] op_sel_hi:[1,0,1] neg_lo:[1,0,0]
    v_pk_mul_f32 v[72:73], v[70:71], v[70:71] op_sel_hi:[0,1]
    v_pk_fma_f32 v[72:73], v[70:71], v[70:71], v[72:73] op_sel:[1,1,0] op_sel_hi:[1,0,1] neg_lo:[1,0,0]
    v_pk_mul_f32 v[78:79], v[76:77], v[64:65] op_sel_hi:[0,1]
    v_pk_fma_f32 v[78:79], v[76:77], v[64:65], v[78:79] op_sel:[1,1,0] op_sel_hi:[1,0,1] neg_lo:[1,0,0]
    v_cvt_pk_bf16_f32 v23, v76, -v77
    v_pk_mul_f32 v[80:81], v[76:77], v[70:71] op_sel_hi:[0,1]
    v_pk_fma_f32 v[80:81], v[76:77], v[70:71], v[80:81] op_sel:[1,1,0] op_sel_hi:[1,0,1] neg_lo:[1,0,0]
    v_cvt_pk_bf16_f32 v20, v78, -v79
    ds_write_addtid_b32 v23 offset:0
    ds_write_addtid_b32 v20 offset:544
    v_pk_mul_f32 v[82:83], v[78:79], v[70:71] op_sel_hi:[0,1]
    v_pk_fma_f32 v[82:83], v[78:79], v[70:71], v[82:83] op_sel:[1,1,0] op_sel_hi:[1,0,1] neg_lo:[1,0,0]
    v_cvt_pk_bf16_f32 v21, v80, -v81
    v_pk_mul_f32 v[84:85], v[76:77], v[72:73] op_sel_hi:[0,1]
    v_pk_fma_f32 v[84:85], v[76:77], v[72:73], v[84:85] op_sel:[1,1,0] op_sel_hi:[1,0,1] neg_lo:[1,0,0]
    v_cvt_pk_bf16_f32 v22, v82, -v83
    ds_write_addtid_b32 v21 offset:1088
    ds_write_addtid_b32 v22 offset:1632
    v_pk_mul_f32 v[86:87], v[78:79], v[72:73] op_sel_hi:[0,1]
    v_pk_fma_f32 v[86:87], v[78:79], v[72:73], v[86:87] op_sel:[1,1,0] op_sel_hi:[1,0,1] neg_lo:[1,0,0]
    v_cvt_pk_bf16_f32 v23, v84, -v85
    v_pk_mul_f32 v[88:89], v[80:81], v[72:73] op_sel_hi:[0,1]
    v_pk_fma_f32 v[88:89], v[80:81], v[72:73], v[88:89] op_sel:[1,1,0] op_sel_hi:[1,0,1] neg_lo:[1,0,0]
    v_cvt_pk_bf16_f32 v20, v86, -v87
    ds_write_addtid_b32 v23 offset:2176
    ds_write_addtid_b32 v20 offset:2720
    v_pk_mul_f32 v[90:91], v[82:83], v[72:73] op_sel_hi:[0,1]
    v_pk_fma_f32 v[90:91], v[82:83], v[72:73], v[90:91] op_sel:[1,1,0] op_sel_hi:[1,0,1] neg_lo:[1,0,0]
    v_cvt_pk_bf16_f32 v21, v88, -v89
    v_pk_mul_f32 v[92:93], v[76:77], v[66:67] op_sel_hi:[0,1]
    v_pk_fma_f32 v[92:93], v[76:77], v[66:67], v[92:93] op_sel:[1,1,0] op_sel_hi:[1,0,1] neg_lo:[1,0,0]
    v_cvt_pk_bf16_f32 v22, v90, -v91
    ds_write_addtid_b32 v21 offset:3264
    ds_write_addtid_b32 v22 offset:3808
    v_pk_mul_f32 v[56:57], v[80:81], v[66:67] op_sel_hi:[0,1]
    v_pk_fma_f32 v[56:57], v[80:81], v[66:67], v[56:57] op_sel:[1,1,0] op_sel_hi:[1,0,1] neg_lo:[1,0,0]
    v_cvt_pk_bf16_f32 v23, v92, -v93
    ds_write_addtid_b32 v23 offset:4352
    s_getreg_b32 s93, hwreg(HW_REG_IB_STS, 0, 4)
    s_cmp_lt_u32 s93, s94
    s_cbranch_scc0 L_np3
    s_mov_b64 exec, 1
    buffer_store_dwordx4 v[44:47], v3, s[8:11], s91 offen sc1
    s_mov_b64 exec, -1
    s_mov_b32 s94, 0
L_np3:
    v_pk_mul_f32 v[94:95], v[84:85], v[66:67] op_sel_hi:[0,1]
    v_pk_fma_f32 v[94:95], v[84:85], v[66:67], v[94:95] op_sel:[1,1,0] op_sel_hi:[1,0,1] neg_lo:[1,0,0]
    v_cvt_pk_bf16_f32 v20, v56, -v57
    v_pk_mul_f32 v[58:59], v[88:89], v[66:67] op_sel_hi:[0,1]
    v_pk_fma_f32 v[58:59], v[88:89], v[66:67], v[58:59] op_sel:[1,1,0] op_sel_hi:[1,0,1] neg_lo:[1,0,0]
    v_cvt_pk_bf16_f32 v21, v94, -v95
    ds_write_addtid_b32 v20 offset:4896
    ds_write_addtid_b32 v21 offset:5440
    v_pk_mul_f32 v[96:97], v[76:77], v[74:75] op_sel_hi:[0,1]
    v_pk_fma_f32 v[96:97], v[76:77], v[74:75], v[96:97] op_sel:[1,1,0] op_sel_hi:[1,0,1] neg_lo:[1,0,0]
    v_cvt_pk_bf16_f32 v22, v58, -v59
    v_pk_mul_f32 v[98:99], v[92:93], v[74:75] op_sel_hi:[0,1]
    v_pk_fma_f32 v[98:99], v[92:93], v[74:75], v[98:99] op_sel:[1,1,0] op_sel_hi:[1,0,1] neg_lo:[1,0,0]
    v_cvt_pk_bf16_f32 v23, v96, -v97
    ds_write_addtid_b32 v22 offset:5984
    ds_write_addtid_b32 v23 offset:6528
    v_pk_mul_f32 v[100:101], v[76:77], v[68:69] op_sel_hi:[0,1]
    v_pk_fma_f32 v[100:101], v[76:77], v[68:69], v[100:101] op_sel:[1,1,0] op_sel_hi:[1,0,1] neg_lo:[1,0,0]
    v_cvt_pk_bf16_f32 v20, v98, -v99
    v_pk_mul_f32 v[60:61], v[92:93], v[68:69] op_sel_hi:[0,1]
    v_pk_fma_f32 v[60:61], v[92:93], v[68:69], v[60:61] op_sel:[1,1,0] op_sel_hi:[1,0,1] neg_lo:[1,0,0]
    v_cvt_pk_bf16_f32 v21, v100, -v101
    ds_write_addtid_b32 v20 offset:7072
    ds_write_addtid_b32 v21 offset:7616
    v_pk_mul_f32 v[62:63], v[96:97], v[68:69] op_sel_hi:[0,1]
    v_pk_fma_f32 v[62:63], v[96:97], v[68:69], v[62:63] op_sel:[1,1,0] op_sel_hi:[1,0,1] neg_lo:[1,0,0]
    v_cvt_pk_bf16_f32 v22, v60, -v61
    v_pk_mul_f32 v[56:57], v[98:99], v[68:69] op_sel_hi:[0,1]
    v_pk_fma_f32 v[56:57], v[98:99], v[68:69], v[56:57] op_sel:[1,1,0] op_sel_hi:[1,0,1] neg_lo:[1,0,0]
    v_cvt_pk_bf16_f32 v23, v62, -v63
    ds_write_addtid_b32 v22 offset:8160
    ds_write_addtid_b32 v23 offset:8704
    v_pk_mul_f32 v[58:59], v[100:101], v[68:69] op_sel_hi:[0,1]
    v_pk_fma_f32 v[58:59], v[100:101], v[68:69], v[58:59] op_sel:[1,1,0] op_sel_hi:[1,0,1] neg_lo:[1,0,0]
    v_cvt_pk_bf16_f32 v20, v56, -v57
    v_pk_mul_f32 v[60:61], v[84:85], v[74:75] op_sel_hi:[0,1]
    v_pk_fma_f32 v[60:61], v[84:85], v[74:75], v[60:61] op_sel:[1,1,0] op_sel_hi:[1,0,1] neg_lo:[1,0,0]
    v_cvt_pk_bf16_f32 v21, v58, -v59
    ds_write_addtid_b32 v20 offset:9248
    ds_write_addtid_b32 v21 offset:9792
    v_pk_mul_f32 v[62:63], v[94:95], v[74:75] op_sel_hi:[0,1]
    v_pk_fma_f32 v[62:63], v[94:95], v[74:75], v[62:63] op_sel:[1,1,0] op_sel_hi:[1,0,1] neg_lo:[1,0,0]
    v_cvt_pk_bf16_f32 v22, v60, -v61
    v_cvt_pk_bf16_f32 v23, v62, -v63
    ds_write_addtid_b32 v22 offset:10880
    ds_write_addtid_b32 v23 offset:11424
    s_cmp_eq_u32 s94, 0
    s_cbranch_scc1 L_np4
    s_waitcnt vmcnt(2)
    s_mov_b64 exec, 1
    buffer_store_dwordx4 v[44:47], v3, s[8:11], s91 offen sc1
    s_mov_b64 exec, -1
    s_mov_b32 s94, 0
L_np4:
    s_waitcnt lgkmcnt(0)
    s_barrier
    ds_read_b128 v[64:67], v202 offset:0
    ds_read_b128 v[68:71], v201 offset:0
    ds_read_b128 v[72:75], v201 offset:8704
    ds_read_b128 v[76:79], v202 offset:64
    ds_read_b128 v[80:83], v201 offset:64
    ds_read_b128 v[84:87], v201 offset:8768
    ds_read_b128 v[88:91], v202 offset:128
    ds_read_b128 v[92:95], v201 offset:128
    ds_read_b128 v[96:99], v201 offset:8832
    ds_read_b128 v[100:103], v202 offset:192
    ds_read_b128 v[104:107], v201 offset:192
    ds_read_b128 v[108:111], v201 offset:8896
    ds_read_b128 v[112:115], v202 offset:256
    ds_read_b128 v[116:119], v201 offset:256
    ds_read_b128 v[120:123], v201 offset:8960
    s_waitcnt lgkmcnt(13)
    v_mfma_f32_16x16x32_bf16 v[16:19], v[68:71], v[64:67], 0
    s_waitcnt lgkmcnt(12)
    v_mfma_f32_16x16x32_bf16 v[20:23], v[72:75], v[64:67], 0
    ds_read_b128 v[124:127], v202 offset:320
    ds_read_b128 v[128:131], v201 offset:320
    ds_read_b128 v[132:135], v201 offset:9024
    s_waitcnt lgkmcnt(13)
    v_mfma_f32_16x16x32_bf16 v[16:19], v[80:83], v[76:79], v[16:19]
    s_waitcnt lgkmcnt(12)
    v_mfma_f32_16x16x32_bf16 v[20:23], v[84:87], v[76:79], v[20:23]
    ds_read_b128 v[136:139], v202 offset:384
    ds_read_b128 v[140:143], v201 offset:384
    ds_read_b128 v[144:147], v201 offset:9088
    s_waitcnt lgkmcnt(13)
    v_mfma_f32_16x16x32_bf16 v[16:19], v[92:95], v[88:91], v[16:19]
    s_waitcnt lgkmcnt(12)
    v_mfma_f32_16x16x32_bf16 v[20:23], v[96:99], v[88:91], v[20:23]
    ds_read_b128 v[148:151], v202 offset:448
    ds_read_b128 v[152:155], v201 offset:448
    ds_read_b128 v[156:159], v201 offset:9152
    s_waitcnt lgkmcnt(13)
    v_mfma_f32_16x16x32_bf16 v[16:19], v[104:107], v[100:103], v[16:19]
    s_waitcnt lgkmcnt(12)
    v_mfma_f32_16x16x32_bf16 v[20:23], v[108:111], v[100:103], v[20:23]
    s_waitcnt lgkmcnt(10)
    v_mfma_f32_16x16x32_bf16 v[16:19], v[116:119], v[112:115], v[16:19]
    s_waitcnt lgkmcnt(9)
    v_mfma_f32_16x16x32_bf16 v[20:23], v[120:123], v[112:115], v[20:23]
    s_waitcnt lgkmcnt(7)
    v_mfma_f32_16x16x32_bf16 v[16:19], v[128:131], v[124:127], v[16:19]
    s_waitcnt lgkmcnt(6)
    v_mfma_f32_16x16x32_bf16 v[20:23], v[132:135], v[124:127], v[20:23]
    s_waitcnt lgkmcnt(4)
    v_mfma_f32_16x16x32_bf16 v[16:19], v[140:143], v[136:139], v[16:19]
    s_waitcnt lgkmcnt(3)
    v_mfma_f32_16x16x32_bf16 v[20:23], v[144:147], v[136:139], v[20:23]
    s_waitcnt lgkmcnt(1)
    v_mfma_f32_16x16x32_bf16 v[16:19], v[152:155], v[148:151], v[16:19]
    s_waitcnt lgkmcnt(0)
    v_mfma_f32_16x16x32_bf16 v[20:23], v[156:159], v[148:151], v[20:23]
    s_lshl_b32 s4, s3, 12
    s_add_u32 s4, s4, 0xb40000
    s_nop 3
    v_cvt_pk_bf16_f32 v16, v16, v17
    v_cvt_pk_bf16_f32 v18, v18, v19
    v_cvt_pk_bf16_f32 v20, v20, v21
    v_cvt_pk_bf16_f32 v22, v22, v23
    ds_write_b16 v204, v16
    ds_write_b16_d16_hi v205, v16
    ds_write_b16 v206, v18
    ds_write_b16_d16_hi v207, v18
    ds_write_b16 v208, v20
    ds_write_b16_d16_hi v209, v20
    ds_write_b16 v210, v22
    ds_write_b16_d16_hi v211, v22
    s_waitcnt lgkmcnt(0)
    s_barrier
    ds_read_u16 v64, v212
    ds_read_u16 v65, v213
    ds_read_u16 v66, v214
    ds_read_u16 v67, v215
    ds_read_u16 v68, v216
    ds_read_u16 v69, v217
    ds_read_u16 v70, v218
    ds_read_u16 v71, v219
    ds_read_u16 v72, v220
    ds_read_u16 v73, v221
    ds_read_u16 v74, v222
    ds_read_u16 v75, v223
    ds_read_u16 v76, v224
    ds_read_u16 v77, v225
    ds_read_u16 v78, v226
    ds_read_u16 v79, v227
    ds_read_u16 v80, v228
    ds_read_u16 v81, v229
    ds_read_u16 v82, v230
    buffer_load_dwordx4 v[160:163], v3, s[8:11], s4 offen offset:0 sc1
    buffer_load_dwordx4 v[164:167], v3, s[8:11], s4 offen offset:1024 sc1
    buffer_load_dwordx4 v[168:171], v3, s[8:11], s4 offen offset:2048 sc1
    buffer_load_dwordx4 v[172:175], v3, s[8:11], s4 offen offset:3072 sc1
    s_lshl_b32 s40, s80, 8
    s_sub_u32 s40, 256, s40
    s_add_u32 s41, s76, s40
    v_add_u32 v247, s41, v247
    s_add_u32 s41, s77, 48
    s_add_u32 s41, s41, s40
    v_add_u32 v246, s41, v246
    s_lshl_b32 s82, s80, 10
    s_add_u32 s41, s76, 5024
    s_add_u32 s41, s41, s82
    v_add_u32 v249, s41, v248
    s_add_u32 s41, s77, 25856
    s_lshl_b32 s40, s80, 11
    s_add_u32 s42, s40, s41
    v_add_u32 v240, s42, v3
    s_sub_u32 s42, s41, s40
    s_add_u32 s42, s42, 2048
    v_add_u32 v241, s42, v3
    s_lshl_b32 s40, s3, 10
    s_add_u32 s40, s40, 16640
    v_add_u32 v234, s40, v233
    v_add_u32 v235, 131072, v234
    s_waitcnt lgkmcnt(0)
    s_nop 0
    v_lshl_or_b32 v96, v68, 16, v67
    v_lshl_or_b32 v97, v70, 16, v69
    v_lshl_or_b32 v98, v72, 16, v71
    v_lshl_or_b32 v99, v74, 16, v73
    v_lshl_or_b32 v100, v76, 16, v75
    v_lshl_or_b32 v101, v78, 16, v77
    v_lshl_or_b32 v102, v80, 16, v79
    v_lshl_or_b32 v103, v82, 16, v81
    ds_write_b128 v231, v[96:99] offset:0
    ds_write_b128 v231, v[100:103] offset:16
    v_lshl_or_b32 v104, v67, 16, v66
    v_lshl_or_b32 v105, v69, 16, v68
    v_lshl_or_b32 v106, v71, 16, v70
    v_lshl_or_b32 v107, v73, 16, v72
    v_lshl_or_b32 v108, v75, 16, v74
    v_lshl_or_b32 v109, v77, 16, v76
    v_lshl_or_b32 v110, v79, 16, v78
    v_lshl_or_b32 v111, v81, 16, v80
    ds_write_b128 v231, v[104:107] offset:4160
    ds_write_b128 v231, v[108:111] offset:4176
    s_mov_b32 s72, 0
    s_branch L_pa_c
L_pa:
    buffer_load_dwordx4 v[160:163], v3, s[8:11], s4 offen offset:0 sc1
    buffer_load_dwordx4 v[164:167], v3, s[8:11], s4 offen offset:1024 sc1
    buffer_load_dwordx4 v[168:171], v3, s[8:11], s4 offen offset:2048 sc1
    buffer_load_dwordx4 v[172:175], v3, s[8:11], s4 offen offset:3072 sc1
L_pa_c:
    s_add_u32 s72, s72, 1
    s_waitcnt vmcnt(0)
    v_xor_b32 v2, s28, v163
    v_xor_b32 v167, s28, v167
    v_xor_b32 v171, s28, v171
    v_xor_b32 v175, s28, v175
    v_or3_b32 v2, v2, v167, v171
    v_or_b32 v2, v2, v175
    v_cmp_ne_u32 vcc, 0, v2
    s_cmp_gt_u32 s72, 262144
    s_cbranch_scc1 L_pa_x
    s_cbranch_vccnz L_pa
L_pa_x:
    s_mul_i32 s4, s29, 8704
    s_lshl_b32 s5, s3, 10
    s_add_u32 s4, s4, s5
    s_add_u32 s4, s4, 0x0
    s_nop 0
    s_add_u32 s5, s4, 4352
    buffer_load_dword v176, v233, s[8:11], s4 offen offset:0 sc1
    buffer_load_dword v177, v233, s[8:11], s5 offen offset:0 sc1
    buffer_load_dword v178, v233, s[8:11], s4 offen offset:256 sc1
    buffer_load_dword v179, v233, s[8:11], s5 offen offset:256 sc1
    buffer_load_dword v180, v233, s[8:11], s4 offen offset:512 sc1
    buffer_load_dword v181, v233, s[8:11], s5 offen offset:512 sc1
    buffer_load_dword v182, v233, s[8:11], s4 offen offset:768 sc1
    buffer_load_dword v183, v233, s[8:11], s5 offen offset:768 sc1
    v_lshl_or_b32 v112, v66, 16, v65
    v_lshl_or_b32 v113, v68, 16, v67
    v_lshl_or_b32 v114, v70, 16, v69
    v_lshl_or_b32 v115, v72, 16, v71
    v_lshl_or_b32 v116, v74, 16, v73
    v_lshl_or_b32 v117, v76, 16, v75
    v_lshl_or_b32 v118, v78, 16, v77
    v_lshl_or_b32 v119, v80, 16, v79
    ds_write_b128 v231, v[112:115] offset:8320
    ds_write_b128 v231, v[116:119] offset:8336
    v_lshl_or_b32 v120, v65, 16, v64
    v_lshl_or_b32 v121, v67, 16, v66
    v_lshl_or_b32 v122, v69, 16, v68
    v_lshl_or_b32 v123, v71, 16, v70
    v_lshl_or_b32 v124, v73, 16, v72
    v_lshl_or_b32 v125, v75, 16, v74
    v_lshl_or_b32 v126, v77, 16, v76
    v_lshl_or_b32 v127, v79, 16, v78
    ds_write_b128 v231, v[120:123] offset:12480
    ds_write_b128 v231, v[124:127] offset:12496
    v_mov_b32 v20, 0x3f803f80
    v_mov_b32 v21, 0x3f803f80
    v_mov_b32 v22, 0x3f803f80
    v_mov_b32 v23, 0x3f803f80
    s_mul_i32 s76, s81, 4352
    s_add_u32 s76, s76, s82
    s_add_u32 s77, s76, 0x220000
    v_lshlrev_b32 v251, 16, v251
    v_mov_b32 v252, s28
    v_mov_b32 v253, 0
    v_lshlrev_b32 v250, 4, v0
    s_lshl_b32 s82, s29, 4
    s_add_u32 s83, s82, 0xb78000
    s_add_u32 s82, s82, 0xb70000
    s_mov_b32 s85, 0xb70000
    s_mov_b32 s86, 0xb78000
    s_mul_i32 s90, s3, 557056
    s_add_u32 s90, s90, 0x220000
    s_min_u32 s40, s31, 27
    s_mul_i32 s41, s40, 37
    s_lshr_b32 s36, s41, 8
    s_mul_i32 s41, s36, 7
    s_sub_u32 s41, s40, s41
    s_lshr_b32 s66, s30, 1
    s_lshl_b32 s66, s66, 2
    s_add_u32 s66, s66, s36
    s_and_b32 s7, s30, 1
    s_mul_i32 s7, s7, 7
    s_add_u32 s7, s7, s41
    v_lshlrev_b32 v36, 2, v4
    v_xor_b32 v36, v5, v36
    v_lshlrev_b32 v36, 4, v36
    v_mul_u32_u24 v184, 3584, v4
    v_add_u32_e64 v184, v184, v36
    v_add_u32 v185, 13312, v184
    v_add_u32 v186, 26624, v184
    v_add_u32 v187, 39936, v184
    s_mul_i32 s71, s3, 458752
    s_lshl_b32 s40, s7, 8
    s_add_u32 s71, s71, s40
    s_lshl_b32 s89, s3, 13
    s_add_u32 s33, s71, 458752
    s_mul_i32 s40, s36, 114688
    s_add_u32 s71, s71, s40
    v_and_b32 v129, 0xffff0000, v160
    v_lshlrev_b32 v128, 16, v160
    v_mov_b32 v136, v161
    v_mov_b32 v137, v162
    v_and_b32 v131, 0xffff0000, v164
    v_lshlrev_b32 v130, 16, v164
    v_mov_b32 v138, v165
    v_mov_b32 v139, v166
    v_and_b32 v133, 0xffff0000, v168
    v_lshlrev_b32 v132, 16, v168
    v_mov_b32 v140, v169
    v_mov_b32 v141, v170
    v_and_b32 v135, 0xffff0000, v172
    v_lshlrev_b32 v134, 16, v172
    v_mov_b32 v142, v173
    v_mov_b32 v143, v174
    s_waitcnt vmcnt(6)
    v_lshlrev_b32 v144, 16, v176
    v_and_b32 v145, 0xffff0000, v176
    v_pk_add_f32 v[144:145], v[144:145], v[128:129] neg_lo:[0,1] neg_hi:[0,1]
    v_cvt_pk_bf16_f32 v176, v144, v145
    v_lshlrev_b32 v144, 16, v176
    v_and_b32 v145, 0xffff0000, v176
    v_pk_mul_f32 v[144:145], v[144:145], v[136:137]
    v_cvt_pk_bf16_f32 v176, v144, v145
    v_lshlrev_b32 v146, 16, v177
    v_and_b32 v147, 0xffff0000, v177
    v_pk_add_f32 v[146:147], v[146:147], v[128:129] neg_lo:[0,1] neg_hi:[0,1]
    v_cvt_pk_bf16_f32 v177, v146, v147
    v_lshlrev_b32_e64 v146, 16, v177
    v_and_b32 v147, 0xffff0000, v177
    v_pk_mul_f32 v[146:147], v[146:147], v[136:137]
    v_cvt_pk_bf16_f32 v177, v146, v147
    ds_write_b32 v234, v176 offset:456
    ds_write_b32 v234, v176 offset:5024
    ds_write_b32 v235, v177 offset:456
    ds_write_b32 v235, v177 offset:5024
    s_waitcnt vmcnt(4)
    v_lshlrev_b32 v148, 16, v178
    v_and_b32 v149, 0xffff0000, v178
    v_pk_add_f32 v[148:149], v[148:149], v[130:131] neg_lo:[0,1] neg_hi:[0,1]
    v_cvt_pk_bf16_f32 v178, v148, v149
    v_lshlrev_b32 v148, 16, v178
    v_and_b32 v149, 0xffff0000, v178
    v_pk_mul_f32 v[148:149], v[148:149], v[138:139]
    v_cvt_pk_bf16_f32 v178, v148, v149
    v_lshlrev_b32 v150, 16, v179
    v_and_b32 v151, 0xffff0000, v179
    v_pk_add_f32 v[150:151], v[150:151], v[130:131] neg_lo:[0,1] neg_hi:[0,1]
    v_cvt_pk_bf16_f32 v179, v150, v151
    v_lshlrev_b32_e64 v150, 16, v179
    v_and_b32 v151, 0xffff0000, v179
    v_pk_mul_f32 v[150:151], v[150:151], v[138:139]
    v_cvt_pk_bf16_f32 v179, v150, v151
    ds_write_b32 v234, v178 offset:712
    ds_write_b32 v234, v178 offset:5280
    ds_write_b32 v235, v179 offset:712
    ds_write_b32 v235, v179 offset:5280
    s_waitcnt vmcnt(2)
    v_lshlrev_b32 v152, 16, v180
    v_and_b32 v153, 0xffff0000, v180
    v_pk_add_f32 v[152:153], v[152:153], v[132:133] neg_lo:[0,1] neg_hi:[0,1]
    v_cvt_pk_bf16_f32 v180, v152, v153
    v_lshlrev_b32 v152, 16, v180
    v_and_b32 v153, 0xffff0000, v180
    v_pk_mul_f32 v[152:153], v[152:153], v[140:141]
    v_cvt_pk_bf16_f32 v180, v152, v153
    v_lshlrev_b32 v154, 16, v181
    v_and_b32 v155, 0xffff0000, v181
    v_pk_add_f32 v[154:155], v[154:155], v[132:133] neg_lo:[0,1] neg_hi:[0,1]
    v_cvt_pk_bf16_f32 v181, v154, v155
    v_lshlrev_b32_e64 v154, 16, v181
    v_and_b32 v155, 0xffff0000, v181
    v_pk_mul_f32 v[154:155], v[154:155], v[140:141]
    v_cvt_pk_bf16_f32 v181, v154, v155
    ds_write_b32 v234, v180 offset:968
    ds_write_b32 v234, v180 offset:5536
    ds_write_b32 v235, v181 offset:968
    ds_write_b32 v235, v181 offset:5536
    s_waitcnt vmcnt(0)
    v_lshlrev_b32 v156, 16, v182
    v_and_b32 v157, 0xffff0000, v182
    v_pk_add_f32 v[156:157], v[156:157], v[134:135] neg_lo:[0,1] neg_hi:[0,1]
    v_cvt_pk_bf16_f32 v182, v156, v157
    v_lshlrev_b32 v156, 16, v182
    v_and_b32 v157, 0xffff0000, v182
    v_pk_mul_f32 v[156:157], v[156:157], v[142:143]
    v_cvt_pk_bf16_f32 v182, v156, v157
    v_lshlrev_b32 v158, 16, v183
    v_and_b32 v159, 0xffff0000, v183
    v_pk_add_f32 v[158:159], v[158:159], v[134:135] neg_lo:[0,1] neg_hi:[0,1]
    v_cvt_pk_bf16_f32 v183, v158, v159
    v_lshlrev_b32_e64 v158, 16, v183
    v_and_b32 v159, 0xffff0000, v183
    v_pk_mul_f32 v[158:159], v[158:159], v[142:143]
    v_cvt_pk_bf16_f32 v183, v158, v159
    ds_write_b32 v234, v182 offset:1224
    ds_write_b32 v234, v182 offset:5792
    ds_write_b32 v235, v183 offset:1224
    ds_write_b32 v235, v183 offset:5792
    s_waitcnt lgkmcnt(0)
    s_barrier
    ds_read_b64 v[28:29], v249
    ds_read_b64 v[30:31], v249 offset:512
    ds_read_b64 v[32:33], v249 offset:2048
    ds_read_b64 v[34:35], v249 offset:2560
    buffer_load_dwordx2 v[12:13], v248, s[8:11], s76 offen sc1
    buffer_load_dwordx2 v[14:15], v248, s[8:11], s76 offen offset:512 sc1
    buffer_load_dwordx2 v[16:17], v248, s[8:11], s76 offen offset:2048 sc1
    buffer_load_dwordx2 v[18:19], v248, s[8:11], s76 offen offset:2560 sc1
    ds_read_b128 v[72:75], v246 offset:3776
    ds_read_b128 v[76:79], v247 offset:192
    ds_read_b128 v[80:83], v247 offset:704
    ds_read_b128 v[84:87], v246 offset:3264
    ds_read_b128 v[88:91], v247 offset:1216
    ds_read_b128 v[92:95], v246 offset:2752
    ds_read_b128 v[96:99], v247 offset:1728
    ds_read_b128 v[100:103], v246 offset:2240
    ds_read_b128 v[104:107], v246 offset:3712
    ds_read_b128 v[108:111], v247 offset:128
    s_waitcnt lgkmcnt(6)
    v_mfma_f32_16x16x32_bf16 v[40:43], v[72:75], v[76:79], 0
    ds_read_b128 v[112:115], v247 offset:640
    v_mfma_f32_16x16x32_bf16 v[44:47], v[72:75], v[80:83], 0
    ds_read_b128 v[116:119], v246 offset:3200
    s_add_u32 m0, s89, 32768
    v_mfma_f32_16x16x32_bf16 v[44:47], v[84:87], v[76:79], v[44:47]
    ds_read_b128 v[120:123], v247 offset:1152
    v_mfma_f32_16x16x32_bf16 v[48:51], v[84:87], v[80:83], 0
    ds_read_b128 v[124:127], v246 offset:2688
    buffer_load_dwordx4 v184, s[16:19], s71 offen offset:0  lds
    s_waitcnt lgkmcnt(8)
    v_mfma_f32_16x16x32_bf16 v[48:51], v[72:75], v[88:91], v[48:51]
    ds_read_b128 v[128:131], v247 offset:1664
    v_mfma_f32_16x16x32_bf16 v[48:51], v[92:95], v[76:79], v[48:51]
    ds_read_b128 v[132:135], v246 offset:2176
    v_mfma_f32_16x16x32_bf16 v[52:55], v[84:87], v[88:91], 0
    buffer_load_dwordx4 v185, s[16:19], s71 offen offset:1024  lds
    v_lshlrev_b32 v160, 16, v28
    v_mfma_f32_16x16x32_bf16 v[52:55], v[92:95], v[80:83], v[52:55]
    ds_read_b128 v[136:139], v246 offset:3648
    v_and_b32 v161, 0xffff0000, v28
    s_waitcnt lgkmcnt(7)
    v_mfma_f32_16x16x32_bf16 v[52:55], v[72:75], v[96:99], v[52:55]
    ds_read_b128 v[140:143], v247 offset:64
    v_mul_f32 v160, v160, v251
    v_mfma_f32_16x16x32_bf16 v[52:55], v[100:103], v[76:79], v[52:55]
    ds_read_b128 v[144:147], v247 offset:576
    buffer_load_dwordx4 v186, s[16:19], s71 offen offset:2048  lds
    v_mul_f32 v161, v161, v251
    v_mfma_f32_16x16x32_bf16 v[40:43], v[104:107], v[108:111], v[40:43]
    ds_read_b128 v[148:151], v246 offset:3136
    v_cvt_pk_bf16_f32 v160, v160, v161
    s_waitcnt lgkmcnt(8)
    v_mfma_f32_16x16x32_bf16 v[44:47], v[104:107], v[112:115], v[44:47]
    ds_read_b128 v[152:155], v247 offset:1088
    v_and_b32 v161, 0xffff0000, v160
    v_mfma_f32_16x16x32_bf16 v[44:47], v[116:119], v[108:111], v[44:47]
    ds_read_b128 v[156:159], v246 offset:2624
    buffer_load_dwordx4 v187, s[16:19], s71 offen offset:3072  lds
    v_lshlrev_b32 v160, 16, v160
    v_mfma_f32_16x16x32_bf16 v[48:51], v[116:119], v[112:115], v[48:51]
    ds_read_b128 v[84:87], v247 offset:1600
    v_lshlrev_b32 v162, 16, v29
    s_waitcnt lgkmcnt(9)
    v_mfma_f32_16x16x32_bf16 v[48:51], v[104:107], v[120:123], v[48:51]
    ds_read_b128 v[88:91], v246 offset:2112
    v_and_b32 v163, 0xffff0000, v29
    v_mfma_f32_16x16x32_bf16 v[48:51], v[124:127], v[108:111], v[48:51]
    ds_read_b128 v[92:95], v246 offset:3584
    s_add_u32 m0, m0, 4096
    v_mul_f32 v162, v162, v251
    v_mfma_f32_16x16x32_bf16 v[52:55], v[116:119], v[120:123], v[52:55]
    v_mul_f32 v163, v163, v251
    v_mfma_f32_16x16x32_bf16 v[52:55], v[124:127], v[112:115], v[52:55]
    v_cvt_pk_bf16_f32 v162, v162, v163
    s_waitcnt lgkmcnt(7)
    v_mfma_f32_16x16x32_bf16 v[52:55], v[104:107], v[128:131], v[52:55]
    ds_read_b128 v[80:83], v247 offset:0
    s_add_u32 s71, s71, 57344
    v_and_b32 v163, 0xffff0000, v162
    v_mfma_f32_16x16x32_bf16 v[52:55], v[132:135], v[108:111], v[52:55]
    ds_read_b128 v[72:75], v247 offset:512
    v_lshlrev_b32 v162, 16, v162
    v_mfma_f32_16x16x32_bf16 v[40:43], v[136:139], v[140:143], v[40:43]
    ds_read_b128 v[96:99], v246 offset:3072
    v_lshlrev_b32 v164, 16, v30
    s_waitcnt lgkmcnt(8)
    v_mfma_f32_16x16x32_bf16 v[44:47], v[136:139], v[144:147], v[44:47]
    ds_read_b128 v[100:103], v247 offset:1024
    buffer_load_dwordx4 v184, s[16:19], s71 offen offset:0  lds
    v_and_b32 v165, 0xffff0000, v30
    v_mfma_f32_16x16x32_bf16 v[44:47], v[148:151], v[140:143], v[44:47]
    ds_read_b128 v[76:79], v246 offset:2560
    v_mul_f32 v164, v164, v251
    v_mfma_f32_16x16x32_bf16 v[48:51], v[148:151], v[144:147], v[48:51]
    ds_read_b128 v[116:119], v247 offset:1536
    buffer_load_dwordx4 v185, s[16:19], s71 offen offset:1024  lds
    v_mul_f32 v165, v165, v251
    s_waitcnt lgkmcnt(9)
    v_mfma_f32_16x16x32_bf16 v[48:51], v[136:139], v[152:155], v[48:51]
    ds_read_b128 v[120:123], v246 offset:2048
    v_cvt_pk_bf16_f32 v164, v164, v165
    v_mfma_f32_16x16x32_bf16 v[48:51], v[156:159], v[140:143], v[48:51]
    ds_read_b128 v[124:127], v246 offset:3776
    v_and_b32 v165, 0xffff0000, v164
    v_mfma_f32_16x16x32_bf16 v[52:55], v[148:151], v[152:155], v[52:55]
    buffer_load_dwordx4 v186, s[16:19], s71 offen offset:2048  lds
    v_lshlrev_b32 v164, 16, v164
    v_mfma_f32_16x16x32_bf16 v[52:55], v[156:159], v[144:147], v[52:55]
    v_lshlrev_b32 v166, 16, v31
    s_waitcnt lgkmcnt(7)
    v_mfma_f32_16x16x32_bf16 v[52:55], v[136:139], v[84:87], v[52:55]
    ds_read_b128 v[112:115], v247 offset:3776
    v_and_b32 v167, 0xffff0000, v31
    v_mfma_f32_16x16x32_bf16 v[52:55], v[88:91], v[140:143], v[52:55]
    ds_read_b128 v[104:107], v247 offset:3264
    buffer_load_dwordx4 v187, s[16:19], s71 offen offset:3072  lds
    v_mul_f32 v166, v166, v251
    v_mfma_f32_16x16x32_bf16 v[40:43], v[92:95], v[80:83], v[40:43]
    ds_read_b128 v[128:131], v247 offset:2752
    v_mul_f32 v167, v167, v251
    s_waitcnt lgkmcnt(8)
    v_mfma_f32_16x16x32_bf16 v[44:47], v[92:95], v[72:75], v[44:47]
    ds_read_b128 v[132:135], v247 offset:2240
    v_cvt_pk_bf16_f32 v166, v166, v167
    v_mfma_f32_16x16x32_bf16 v[44:47], v[96:99], v[80:83], v[44:47]
    ds_read_b128 v[108:111], v246 offset:3264
    s_add_u32 s71, s71, 57344
    s_cmp_ge_u32 s71, s33
    s_cselect_b32 s47, 458752, 0
    s_sub_u32 s71, s71, s47
    v_and_b32 v167, 0xffff0000, v166
    v_mfma_f32_16x16x32_bf16 v[48:51], v[96:99], v[72:75], v[48:51]
    ds_read_b128 v[148:151], v247 offset:1728
    v_lshlrev_b32 v166, 16, v166
    s_waitcnt lgkmcnt(9)
    v_mfma_f32_16x16x32_bf16 v[48:51], v[92:95], v[100:103], v[48:51]
    ds_read_b128 v[152:155], v246 offset:2752
    v_mfma_f32_16x16x32_bf16 v[48:51], v[76:79], v[80:83], v[48:51]
    ds_read_b128 v[156:159], v247 offset:1216
    s_add_u32 m0, s89, 65536
    v_mfma_f32_16x16x32_bf16 v[52:55], v[96:99], v[100:103], v[52:55]
    v_mfma_f32_16x16x32_bf16 v[52:55], v[76:79], v[72:75], v[52:55]
    s_waitcnt lgkmcnt(7)
    v_mfma_f32_16x16x32_bf16 v[52:55], v[92:95], v[116:119], v[52:55]
    ds_read_b128 v[144:147], v246 offset:2240
    buffer_load_dwordx4 v184, s[16:19], s71 offen offset:0  lds
    v_mfma_f32_16x16x32_bf16 v[52:55], v[120:123], v[80:83], v[52:55]
    ds_read_b128 v[136:139], v247 offset:704
    v_mfma_f32_16x16x32_bf16 v[68:71], v[124:127], v[112:115], 0
    ds_read_b128 v[84:87], v246 offset:1728
    s_waitcnt lgkmcnt(7)
    v_mfma_f32_16x16x32_bf16 v[64:67], v[124:127], v[104:107], 0
    ds_read_b128 v[88:91], v247 offset:192
    buffer_load_dwordx4 v185, s[16:19], s71 offen offset:1024  lds
    s_cmp_eq_u32 s80, 1
    s_cbranch_scc1 L_x01
    s_nop 7
    ds_write_b128 v240, v[48:51]
    ds_write_b128 v240, v[52:55] offset:1024
    s_branch L_x02
L_x01:
    s_nop 7
    ds_write_b128 v240, v[40:43]
    ds_write_b128 v240, v[44:47] offset:1024
    v_mov_b32 v40, v48
    v_mov_b32 v41, v49
    v_mov_b32 v42, v50
    v_mov_b32 v43, v51
    v_mov_b32 v44, v52
    v_mov_b32 v45, v53
    v_mov_b32 v46, v54
    v_mov_b32 v47, v55
L_x02:
    s_waitcnt vmcnt(10)
    v_lshlrev_b32 v200, 16, v12
    v_and_b32 v201, 0xffff0000, v12
    v_mfma_f32_16x16x32_bf16 v[60:63], v[124:127], v[128:131], 0
    ds_read_b128 v[140:143], v246 offset:1216
    v_lshlrev_b32 v202, 16, v13
    v_mfma_f32_16x16x32_bf16 v[56:59], v[124:127], v[132:135], 0
    ds_read_b128 v[96:99], v246 offset:704
    v_and_b32 v203, 0xffff0000, v13
    s_waitcnt lgkmcnt(11)
    v_mfma_f32_16x16x32_bf16 v[68:71], v[108:111], v[104:107], v[68:71]
    ds_read_b128 v[100:103], v246 offset:192
    v_lshlrev_b32 v204, 16, v14
    v_mfma_f32_16x16x32_bf16 v[64:67], v[108:111], v[128:131], v[64:67]
    v_and_b32 v205, 0xffff0000, v14
    v_mfma_f32_16x16x32_bf16 v[60:63], v[108:111], v[132:135], v[60:63]
    v_lshlrev_b32 v206, 16, v15
    s_waitcnt lgkmcnt(10)
    v_mfma_f32_16x16x32_bf16 v[56:59], v[108:111], v[148:151], v[56:59]
    ds_read_b128 v[76:79], v246 offset:3712
    v_and_b32 v207, 0xffff0000, v15
    v_mfma_f32_16x16x32_bf16 v[68:71], v[152:155], v[128:131], v[68:71]
    ds_read_b128 v[72:75], v247 offset:3712
    s_waitcnt lgkmcnt(5)
    s_barrier
    ds_read_b128 v[176:179], v241
    ds_read_b128 v[180:183], v241 offset:1024
    v_mfma_f32_16x16x32_bf16 v[64:67], v[152:155], v[132:135], v[64:67]
    ds_read_b128 v[92:95], v247 offset:3200
    v_mfma_f32_16x16x32_bf16 v[60:63], v[152:155], v[148:151], v[60:63]
    v_mfma_f32_16x16x32_bf16 v[56:59], v[152:155], v[156:159], v[56:59]
    ds_read_b128 v[116:119], v247 offset:2688
    v_mfma_f32_16x16x32_bf16 v[68:71], v[144:147], v[132:135], v[68:71]
    ds_read_b128 v[120:123], v247 offset:2176
    v_mfma_f32_16x16x32_bf16 v[64:67], v[144:147], v[148:151], v[64:67]
    s_waitcnt lgkmcnt(3)
    v_pk_add_f32 v[40:41], v[40:41], v[176:177]
    v_pk_add_f32 v[42:43], v[42:43], v[178:179]
    v_pk_add_f32 v[44:45], v[44:45], v[180:181]
    v_pk_add_f32 v[46:47], v[46:47], v[182:183]
    v_cvt_pk_bf16_f32 v40, v40, v41
    v_cvt_pk_bf16_f32 v42, v42, v43
    v_cvt_pk_bf16_f32 v44, v44, v45
    v_cvt_pk_bf16_f32 v46, v46, v47
    v_and_b32 v41, 0xffff0000, v40
    v_lshlrev_b32 v40, 16, v40
    v_and_b32 v43, 0xffff0000, v42
    v_lshlrev_b32 v42, 16, v42
    v_and_b32 v45, 0xffff0000, v44
    v_lshlrev_b32 v44, 16, v44
    v_and_b32 v47, 0xffff0000, v46
    v_lshlrev_b32 v46, 16, v46
    v_pk_add_f32 v[40:41], v[40:41], v[160:161]
    v_pk_add_f32 v[42:43], v[42:43], v[162:163]
    v_pk_add_f32 v[44:45], v[44:45], v[164:165]
    v_pk_add_f32 v[46:47], v[46:47], v[166:167]
    v_cvt_pk_bf16_f32 v40, v40, v41
    v_cvt_pk_bf16_f32 v42, v42, v43
    v_cvt_pk_bf16_f32 v44, v44, v45
    v_cvt_pk_bf16_f32 v46, v46, v47
    v_and_b32 v41, 0xffff0000, v40
    v_lshlrev_b32 v40, 16, v40
    v_and_b32 v43, 0xffff0000, v42
    v_lshlrev_b32 v42, 16, v42
    v_and_b32 v45, 0xffff0000, v44
    v_lshlrev_b32 v44, 16, v44
    v_and_b32 v47, 0xffff0000, v46
    v_lshlrev_b32 v46, 16, v46
    v_pk_add_f32 v[40:41], v[40:41], v[200:201]
    v_pk_add_f32 v[42:43], v[42:43], v[202:203]
    v_pk_add_f32 v[44:45], v[44:45], v[204:205]
    v_pk_add_f32 v[46:47], v[46:47], v[206:207]
    v_cvt_pk_bf16_f32 v216, v40, v41
    v_cvt_pk_bf16_f32 v217, v42, v43
    v_cvt_pk_bf16_f32 v218, v44, v45
    v_cvt_pk_bf16_f32 v219, v46, v47
    buffer_store_dwordx2 v[216:217], v248, s[8:11], s77 offen offset:0 sc1
    buffer_store_dwordx2 v[218:219], v248, s[8:11], s77 offen offset:512 sc1
    v_and_b32 v37, 1, v4
    v_lshlrev_b32 v37, 5, v37
    v_mfma_f32_16x16x32_bf16 v[60:63], v[144:147], v[156:159], v[60:63]
    v_lshl_add_u32 v37, v7, 3, v37
    v_mfma_f32_16x16x32_bf16 v[56:59], v[144:147], v[136:139], v[56:59]
    ds_read_b128 v[80:83], v246 offset:3200
    v_lshl_add_u32 v38, v6, 3, v8
    v_mfma_f32_16x16x32_bf16 v[68:71], v[84:87], v[148:151], v[68:71]
    ds_read_b128 v[112:115], v247 offset:1664
    v_lshl_add_u32 v243, v38, 8, v37
    v_mfma_f32_16x16x32_bf16 v[64:67], v[84:87], v[156:159], v[64:67]
    v_xor_b32_e64 v36, s3, v8
    v_mfma_f32_16x16x32_bf16 v[60:63], v[84:87], v[136:139], v[60:63]
    v_lshl_add_u32 v243, v36, 6, v243
    v_mfma_f32_16x16x32_bf16 v[56:59], v[84:87], v[88:91], v[56:59]
    ds_read_b128 v[124:127], v246 offset:2688
    v_add_u32 v244, 98304, v243
    v_mfma_f32_16x16x32_bf16 v[68:71], v[140:143], v[156:159], v[68:71]
    ds_read_b128 v[104:107], v247 offset:1152
    v_add_u32 v243, 32768, v243
    v_mfma_f32_16x16x32_bf16 v[64:67], v[140:143], v[136:139], v[64:67]
    v_mfma_f32_16x16x32_bf16 v[60:63], v[140:143], v[88:91], v[60:63]
    s_waitcnt vmcnt(4)
    s_barrier
    ds_read_b64_tr_b16 a[0:1], v243 offset:0
    v_mfma_f32_16x16x32_bf16 v[68:71], v[96:99], v[136:139], v[68:71]
    ds_read_b128 v[108:111], v246 offset:2176
    ds_read_b64_tr_b16 a[2:3], v243 offset:1024
    v_mfma_f32_16x16x32_bf16 v[64:67], v[96:99], v[88:91], v[64:67]
    ds_read_b64_tr_b16 a[4:5], v243 offset:4096
    v_mfma_f32_16x16x32_bf16 v[68:71], v[100:103], v[88:91], v[68:71]
    ds_read_b128 v[128:131], v247 offset:640
    ds_read_b64_tr_b16 a[6:7], v243 offset:5120
    v_mfma_f32_16x16x32_bf16 v[68:71], v[76:79], v[72:75], v[68:71]
    buffer_load_dwordx4 v186, s[16:19], s71 offen offset:2048  lds
    ds_read_b64_tr_b16 a[8:9], v243 offset:8192
    s_waitcnt lgkmcnt(11)
    v_mfma_f32_16x16x32_bf16 v[64:67], v[76:79], v[92:95], v[64:67]
    ds_read_b128 v[152:155], v246 offset:1664
    ds_read_b64_tr_b16 a[10:11], v243 offset:9216
    v_mfma_f32_16x16x32_bf16 v[60:63], v[76:79], v[116:119], v[60:63]
    buffer_load_dwordx4 v187, s[16:19], s71 offen offset:3072  lds
    ds_read_b64_tr_b16 a[12:13], v243 offset:12288
    v_mfma_f32_16x16x32_bf16 v[56:59], v[76:79], v[120:123], v[56:59]
    s_add_u32 m0, m0, 4096
    ds_read_b64_tr_b16 a[14:15], v243 offset:13312
    s_waitcnt lgkmcnt(14)
    v_mfma_f32_16x16x32_bf16 v[68:71], v[80:83], v[92:95], v[68:71]
    ds_read_b64_tr_b16 a[16:17], v243 offset:16384
    v_mfma_f32_16x16x32_bf16 v[64:67], v[80:83], v[116:119], v[64:67]
    s_add_u32 s71, s71, 57344
    ds_read_b64_tr_b16 a[18:19], v243 offset:17408
    v_mfma_f32_16x16x32_bf16 v[60:63], v[80:83], v[120:123], v[60:63]
    ds_read_b64_tr_b16 a[20:21], v243 offset:20480
    s_waitcnt lgkmcnt(15)
    v_mfma_f32_16x16x32_bf16 v[56:59], v[80:83], v[112:115], v[56:59]
    buffer_load_dwordx4 v184, s[16:19], s71 offen offset:0  lds
    ds_read_b64_tr_b16 a[22:23], v243 offset:21504
    v_mfma_f32_16x16x32_bf16 v[68:71], v[124:127], v[116:119], v[68:71]
    ds_read_b64_tr_b16 a[24:25], v243 offset:24576
    v_mfma_f32_16x16x32_bf16 v[64:67], v[124:127], v[120:123], v[64:67]
    buffer_load_dwordx4 v185, s[16:19], s71 offen offset:1024  lds
    ds_read_b64_tr_b16 a[26:27], v243 offset:25600
    v_mfma_f32_16x16x32_bf16 v[60:63], v[124:127], v[112:115], v[60:63]
    ds_read_b64_tr_b16 a[28:29], v243 offset:28672
    s_waitcnt lgkmcnt(15)
    v_mfma_f32_16x16x32_bf16 v[56:59], v[124:127], v[104:107], v[56:59]
    buffer_load_dwordx4 v186, s[16:19], s71 offen offset:2048  lds
    ds_read_b64_tr_b16 a[30:31], v243 offset:29696
    v_mfma_f32_16x16x32_bf16 v[68:71], v[108:111], v[120:123], v[68:71]
    v_mfma_f32_16x16x32_bf16 v[64:67], v[108:111], v[112:115], v[64:67]
    buffer_load_dwordx4 v187, s[16:19], s71 offen offset:3072  lds
    v_mfma_f32_16x16x32_bf16 v[60:63], v[108:111], v[104:107], v[60:63]
    s_add_u32 s71, s71, 57344
    s_cmp_ge_u32 s71, s33
    s_cselect_b32 s47, 458752, 0
    s_sub_u32 s71, s71, s47
    s_waitcnt lgkmcnt(11)
    v_mfma_f32_16x16x32_bf16 v[56:59], v[108:111], v[128:131], v[56:59]
    ds_read_b128 v[132:135], v247 offset:128
    v_mfma_f32_16x16x32_bf16 v[68:71], v[152:155], v[112:115], v[68:71]
    s_add_u32 m0, s89, 98304
    v_mfma_f32_16x16x32_bf16 v[64:67], v[152:155], v[104:107], v[64:67]
    v_mfma_f32_16x16x32_bf16 v[60:63], v[152:155], v[128:131], v[60:63]
    buffer_load_dwordx4 v184, s[16:19], s71 offen offset:0  lds
    s_waitcnt lgkmcnt(0)
    v_mfma_f32_16x16x32_bf16 v[56:59], v[152:155], v[132:135], v[56:59]
    ds_read_b128 v[144:147], v246 offset:1152
    s_waitcnt lgkmcnt(0)
    v_mfma_f32_16x16x32_bf16 v[68:71], v[144:147], v[104:107], v[68:71]
    ds_read_b128 v[148:151], v246 offset:640
    buffer_load_dwordx4 v185, s[16:19], s71 offen offset:1024  lds
    v_mfma_f32_16x16x32_bf16 v[64:67], v[144:147], v[128:131], v[64:67]
    ds_read_b128 v[84:87], v246 offset:128
    v_mfma_f32_16x16x32_bf16 v[60:63], v[144:147], v[132:135], v[60:63]
    ds_read_b128 v[156:159], v246 offset:3648
    buffer_load_dwordx4 v186, s[16:19], s71 offen offset:2048  lds
    s_waitcnt vmcnt(9)
    s_barrier
    s_cmp_lg_u32 s3, 0
    s_cbranch_scc1 L_nf0
    s_mov_b64 exec, 1
    buffer_store_dword v252, v253, s[8:11], s82 offen sc1
    s_mov_b64 exec, -1
L_nf0:
    v_lshlrev_b32 v208, 16, v16
    s_waitcnt lgkmcnt(2)
    v_mfma_f32_16x16x32_bf16 v[68:71], v[148:151], v[128:131], v[68:71]
    ds_read_b128 v[140:143], v247 offset:3648
    buffer_load_dwordx4 v187, s[16:19], s71 offen offset:3072  lds
    v_and_b32 v209, 0xffff0000, v16
    v_mfma_f32_16x16x32_bf16 v[64:67], v[148:151], v[132:135], v[64:67]
    ds_read_b128 v[136:139], v247 offset:3136
    v_lshlrev_b32 v210, 16, v17
    s_waitcnt lgkmcnt(3)
    v_mfma_f32_16x16x32_bf16 v[68:71], v[84:87], v[132:135], v[68:71]
    ds_read_b128 v[96:99], v247 offset:2624
    s_add_u32 m0, m0, 4096
    v_and_b32 v211, 0xffff0000, v17
    s_waitcnt lgkmcnt(2)
    v_mfma_f32_16x16x32_bf16 v[68:71], v[156:159], v[140:143], v[68:71]
    ds_read_b128 v[100:103], v247 offset:2112
    v_lshlrev_b32 v212, 16, v18
    s_waitcnt lgkmcnt(2)
    v_mfma_f32_16x16x32_bf16 v[64:67], v[156:159], v[136:139], v[64:67]
    ds_read_b128 v[88:91], v246 offset:3136
    s_add_u32 s71, s71, 57344
    v_and_b32 v213, 0xffff0000, v18
    s_waitcnt lgkmcnt(2)
    v_mfma_f32_16x16x32_bf16 v[60:63], v[156:159], v[96:99], v[60:63]
    ds_read_b128 v[72:75], v247 offset:1600
    v_lshlrev_b32 v214, 16, v19
    s_waitcnt lgkmcnt(2)
    v_mfma_f32_16x16x32_bf16 v[56:59], v[156:159], v[100:103], v[56:59]
    ds_read_b128 v[76:79], v246 offset:2624
    buffer_load_dwordx4 v184, s[16:19], s71 offen offset:0  lds
    v_and_b32 v215, 0xffff0000, v19
    s_waitcnt lgkmcnt(2)
    v_mfma_f32_16x16x32_bf16 v[68:71], v[88:91], v[136:139], v[68:71]
    ds_read_b128 v[92:95], v247 offset:1088
    v_lshlrev_b32_e64 v168, 16, v32
    v_mfma_f32_16x16x32_bf16 v[64:67], v[88:91], v[96:99], v[64:67]
    ds_read_b128 v[80:83], v246 offset:2112
    buffer_load_dwordx4 v185, s[16:19], s71 offen offset:1024  lds
    v_and_b32 v169, 0xffff0000, v32
    v_mfma_f32_16x16x32_bf16 v[60:63], v[88:91], v[100:103], v[60:63]
    ds_read_b128 v[116:119], v247 offset:576
    v_mul_f32 v168, v168, v251
    s_waitcnt lgkmcnt(4)
    v_mfma_f32_16x16x32_bf16 v[56:59], v[88:91], v[72:75], v[56:59]
    ds_read_b128 v[124:127], v246 offset:1600
    buffer_load_dwordx4 v186, s[16:19], s71 offen offset:2048  lds
    v_mul_f32 v169, v169, v251
    s_waitcnt lgkmcnt(4)
    v_mfma_f32_16x16x32_bf16 v[68:71], v[76:79], v[96:99], v[68:71]
    ds_read_b128 v[120:123], v247 offset:64
    buffer_load_dwordx4 v187, s[16:19], s71 offen offset:3072  lds
    v_cvt_pk_bf16_f32 v168, v168, v169
    v_mfma_f32_16x16x32_bf16 v[64:67], v[76:79], v[100:103], v[64:67]
    ds_read_b128 v[108:111], v246 offset:1088
    v_and_b32 v169, 0xffff0000, v168
    v_mfma_f32_16x16x32_bf16 v[60:63], v[76:79], v[72:75], v[60:63]
    ds_read_b128 v[112:115], v246 offset:576
    s_add_u32 s71, s71, 57344
    s_cmp_ge_u32 s71, s33
    s_cselect_b32 s47, 458752, 0
    s_sub_u32 s71, s71, s47
    v_lshlrev_b32 v168, 16, v168
    s_waitcnt lgkmcnt(6)
    v_mfma_f32_16x16x32_bf16 v[56:59], v[76:79], v[92:95], v[56:59]
    ds_read_b128 v[152:155], v246 offset:64
    v_lshlrev_b32 v170, 16, v33
    s_waitcnt lgkmcnt(6)
    v_mfma_f32_16x16x32_bf16 v[68:71], v[80:83], v[100:103], v[68:71]
    ds_read_b128 v[104:107], v246 offset:3584
    s_add_u32 m0, s89, 32768
    v_and_b32 v171, 0xffff0000, v33
    v_mfma_f32_16x16x32_bf16 v[64:67], v[80:83], v[72:75], v[64:67]
    ds_read_b128 v[144:147], v247 offset:3584
    v_mul_f32 v170, v170, v251
    v_mfma_f32_16x16x32_bf16 v[60:63], v[80:83], v[92:95], v[60:63]
    ds_read_b128 v[128:131], v247 offset:3072
    buffer_load_dwordx4 v184, s[16:19], s71 offen offset:0  lds
    v_mul_f32 v171, v171, v251
    s_waitcnt lgkmcnt(7)
    v_mfma_f32_16x16x32_bf16 v[56:59], v[80:83], v[116:119], v[56:59]
    ds_read_b128 v[148:151], v247 offset:2560
    v_cvt_pk_bf16_f32 v170, v170, v171
    v_mfma_f32_16x16x32_bf16 v[68:71], v[124:127], v[72:75], v[68:71]
    ds_read_b128 v[84:87], v247 offset:2048
    buffer_load_dwordx4 v185, s[16:19], s71 offen offset:1024  lds
    v_and_b32 v171, 0xffff0000, v170
    v_mfma_f32_16x16x32_bf16 v[64:67], v[124:127], v[92:95], v[64:67]
    ds_read_b128 v[132:135], v246 offset:3072
    buffer_load_dwordx4 v186, s[16:19], s71 offen offset:2048  lds
    v_lshlrev_b32 v170, 16, v170
    v_mfma_f32_16x16x32_bf16 v[60:63], v[124:127], v[116:119], v[60:63]
    ds_read_b128 v[140:143], v247 offset:1536
    v_lshlrev_b32 v172, 16, v34
    s_waitcnt lgkmcnt(9)
    v_mfma_f32_16x16x32_bf16 v[56:59], v[124:127], v[120:123], v[56:59]
    ds_read_b128 v[156:159], v246 offset:2560
    buffer_load_dwordx4 v187, s[16:19], s71 offen offset:3072  lds
    v_and_b32 v173, 0xffff0000, v34
    v_mfma_f32_16x16x32_bf16 v[68:71], v[108:111], v[92:95], v[68:71]
    ds_read_b128 v[136:139], v247 offset:1024
    v_mul_f32 v172, v172, v251
    v_mfma_f32_16x16x32_bf16 v[64:67], v[108:111], v[116:119], v[64:67]
    s_add_u32 m0, m0, 4096
    v_mul_f32 v173, v173, v251
    v_mfma_f32_16x16x32_bf16 v[60:63], v[108:111], v[120:123], v[60:63]
    v_cvt_pk_bf16_f32 v172, v172, v173
    s_waitcnt lgkmcnt(9)
    v_mfma_f32_16x16x32_bf16 v[68:71], v[112:115], v[116:119], v[68:71]
    ds_read_b128 v[88:91], v246 offset:2048
    s_add_u32 s71, s71, 57344
    v_and_b32 v173, 0xffff0000, v172
    v_mfma_f32_16x16x32_bf16 v[64:67], v[112:115], v[120:123], v[64:67]
    v_lshlrev_b32 v172, 16, v172
    v_mfma_f32_16x16x32_bf16 v[68:71], v[152:155], v[120:123], v[68:71]
    ds_read_b128 v[96:99], v247 offset:512
    buffer_load_dwordx4 v184, s[16:19], s71 offen offset:0  lds
    v_lshlrev_b32 v174, 16, v35
    s_waitcnt lgkmcnt(7)
    v_mfma_f32_16x16x32_bf16 v[68:71], v[104:107], v[144:147], v[68:71]
    ds_read_b128 v[76:79], v246 offset:1536
    v_and_b32 v175, 0xffff0000, v35
    v_mfma_f32_16x16x32_bf16 v[64:67], v[104:107], v[128:131], v[64:67]
    ds_read_b128 v[100:103], v247 offset:0
    buffer_load_dwordx4 v185, s[16:19], s71 offen offset:1024  lds
    v_mul_f32 v174, v174, v251
    v_mfma_f32_16x16x32_bf16 v[60:63], v[104:107], v[148:151], v[60:63]
    ds_read_b128 v[80:83], v246 offset:1024
    buffer_load_dwordx4 v186, s[16:19], s71 offen offset:2048  lds
    v_mul_f32 v175, v175, v251
    s_waitcnt lgkmcnt(8)
    v_mfma_f32_16x16x32_bf16 v[56:59], v[104:107], v[84:87], v[56:59]
    ds_read_b128 v[72:75], v246 offset:512
    v_cvt_pk_bf16_f32 v174, v174, v175
    v_mfma_f32_16x16x32_bf16 v[68:71], v[132:135], v[128:131], v[68:71]
    ds_read_b128 v[124:127], v246 offset:0
    buffer_load_dwordx4 v187, s[16:19], s71 offen offset:3072  lds
    v_and_b32 v175, 0xffff0000, v174
    v_mfma_f32_16x16x32_bf16 v[64:67], v[132:135], v[148:151], v[64:67]
    v_lshlrev_b32 v174, 16, v174
    v_mfma_f32_16x16x32_bf16 v[60:63], v[132:135], v[84:87], v[60:63]
    s_add_u32 s71, s71, 57344
    s_cmp_ge_u32 s71, s33
    s_cselect_b32 s47, 458752, 0
    s_sub_u32 s71, s71, s47
    v_lshl_add_u32 v242, v38, 7, v37
    s_waitcnt lgkmcnt(8)
    v_mfma_f32_16x16x32_bf16 v[56:59], v[132:135], v[140:143], v[56:59]
    v_lshrrev_b32 v36, 1, v8
    v_mfma_f32_16x16x32_bf16 v[68:71], v[156:159], v[148:151], v[68:71]
    v_lshl_add_u32 v242, v36, 6, v242
    v_mfma_f32_16x16x32_bf16 v[64:67], v[156:159], v[84:87], v[64:67]
    v_lshrrev_b32 v36, 3, v1
    v_mfma_f32_16x16x32_bf16 v[60:63], v[156:159], v[140:143], v[60:63]
    v_mul_u32_u24 v188, 4352, v36
    s_waitcnt lgkmcnt(6)
    v_mfma_f32_16x16x32_bf16 v[56:59], v[156:159], v[136:139], v[56:59]
    v_lshlrev_b32 v36, 2, v4
    v_mfma_f32_16x16x32_bf16 v[68:71], v[88:91], v[84:87], v[68:71]
    v_xor_b32 v36, v1, v36
    v_mfma_f32_16x16x32_bf16 v[64:67], v[88:91], v[140:143], v[64:67]
    v_and_b32 v36, 7, v36
    v_mfma_f32_16x16x32_bf16 v[60:63], v[88:91], v[136:139], v[60:63]
    v_lshl_add_u32 v188, v36, 4, v188
    s_waitcnt lgkmcnt(5)
    v_mfma_f32_16x16x32_bf16 v[56:59], v[88:91], v[96:99], v[56:59]
    v_add_u32 v189, 33792, v188
    s_waitcnt lgkmcnt(4)
    v_mfma_f32_16x16x32_bf16 v[68:71], v[76:79], v[140:143], v[68:71]
    v_add_u32 v190, 67584, v188
    v_mfma_f32_16x16x32_bf16 v[64:67], v[76:79], v[136:139], v[64:67]
    v_add_u32 v191, 101376, v188
    v_mfma_f32_16x16x32_bf16 v[60:63], v[76:79], v[96:99], v[60:63]
    v_lshl_add_u32 v245, v6, 2, v8
    s_waitcnt lgkmcnt(3)
    v_mfma_f32_16x16x32_bf16 v[56:59], v[76:79], v[100:103], v[56:59]
    v_lshl_add_u32 v245, v245, 6, v37
    s_waitcnt lgkmcnt(2)
    v_mfma_f32_16x16x32_bf16 v[68:71], v[80:83], v[136:139], v[68:71]
    s_lshl_b32 s70, s3, 12
    v_mfma_f32_16x16x32_bf16 v[64:67], v[80:83], v[96:99], v[64:67]
    s_lshl_b32 s67, s7, 2
    v_mfma_f32_16x16x32_bf16 v[60:63], v[80:83], v[100:103], v[60:63]
    s_add_u32 s67, s67, s3
    s_waitcnt lgkmcnt(1)
    v_mfma_f32_16x16x32_bf16 v[68:71], v[72:75], v[96:99], v[68:71]
    v_mfma_f32_16x16x32_bf16 v[64:67], v[72:75], v[100:103], v[64:67]
    s_waitcnt lgkmcnt(0)
    v_mfma_f32_16x16x32_bf16 v[68:71], v[124:127], v[100:103], v[68:71]
    s_cmp_eq_u32 s80, 1
    s_cbranch_scc1 L_x11
    s_nop 7
    ds_write_b128 v240, v[64:67]
    ds_write_b128 v240, v[68:71] offset:1024
    s_branch L_x12
L_x11:
    s_nop 7
    ds_write_b128 v240, v[56:59]
    ds_write_b128 v240, v[60:63] offset:1024
    v_mov_b32 v56, v64
    v_mov_b32 v57, v65
    v_mov_b32 v58, v66
    v_mov_b32 v59, v67
    v_mov_b32 v60, v68
    v_mov_b32 v61, v69
    v_mov_b32 v62, v70
    v_mov_b32 v63, v71
L_x12:
    s_waitcnt vmcnt(0) lgkmcnt(0)
    s_barrier
    ds_read_b128 v[176:179], v241
    ds_read_b128 v[180:183], v241 offset:1024
    buffer_load_dword v254, v250, s[8:11], s85 offen sc1
    v_mov_b32 v16, v242
    v_xor_b32 v17, 64, v242
    v_add_u32 v18, 0x20000, v16
    v_add_u32 v19, 0x20000, v17
    s_waitcnt lgkmcnt(0)
    v_pk_add_f32 v[56:57], v[56:57], v[176:177]
    v_pk_add_f32 v[58:59], v[58:59], v[178:179]
    v_pk_add_f32 v[60:61], v[60:61], v[180:181]
    v_pk_add_f32 v[62:63], v[62:63], v[182:183]
    v_cvt_pk_bf16_f32 v56, v56, v57
    v_cvt_pk_bf16_f32 v58, v58, v59
    v_cvt_pk_bf16_f32 v60, v60, v61
    v_cvt_pk_bf16_f32 v62, v62, v63
    v_and_b32 v57, 0xffff0000, v56
    v_lshlrev_b32 v56, 16, v56
    v_and_b32 v59, 0xffff0000, v58
    v_lshlrev_b32 v58, 16, v58
    v_and_b32 v61, 0xffff0000, v60
    v_lshlrev_b32 v60, 16, v60
    v_and_b32 v63, 0xffff0000, v62
    v_lshlrev_b32 v62, 16, v62
    v_pk_add_f32 v[56:57], v[56:57], v[168:169]
    v_pk_add_f32 v[58:59], v[58:59], v[170:171]
    v_pk_add_f32 v[60:61], v[60:61], v[172:173]
    v_pk_add_f32 v[62:63], v[62:63], v[174:175]
    v_cvt_pk_bf16_f32 v56, v56, v57
    v_cvt_pk_bf16_f32 v58, v58, v59
    v_cvt_pk_bf16_f32 v60, v60, v61
    v_cvt_pk_bf16_f32 v62, v62, v63
    v_and_b32 v57, 0xffff0000, v56
    v_lshlrev_b32 v56, 16, v56
    v_and_b32 v59, 0xffff0000, v58
    v_lshlrev_b32 v58, 16, v58
    v_and_b32 v61, 0xffff0000, v60
    v_lshlrev_b32 v60, 16, v60
    v_and_b32 v63, 0xffff0000, v62
    v_lshlrev_b32 v62, 16, v62
    v_pk_add_f32 v[56:57], v[56:57], v[208:209]
    v_pk_add_f32 v[58:59], v[58:59], v[210:211]
    v_pk_add_f32 v[60:61], v[60:61], v[212:213]
    v_pk_add_f32 v[62:63], v[62:63], v[214:215]
    v_cvt_pk_bf16_f32 v220, v56, v57
    v_cvt_pk_bf16_f32 v221, v58, v59
    v_cvt_pk_bf16_f32 v222, v60, v61
    v_cvt_pk_bf16_f32 v223, v62, v63
    buffer_store_dwordx2 v[220:221], v248, s[8:11], s77 offen offset:2048 sc1
    buffer_store_dwordx2 v[222:223], v248, s[8:11], s77 offen offset:2560 sc1
    s_cmp_ge_u32 s31, 28
    s_cbranch_scc1 L_sp
    v_mfma_f32_32x32x16_bf16 v[128:143], a[0:3], v[20:23], 0
    ds_read_b64_tr_b16 a[32:33], v243 offset:32768
    ds_read_b64_tr_b16 a[34:35], v243 offset:33792
    ds_read_b64_tr_b16 a[36:37], v243 offset:36864
    s_lshl_b32 s4, s66, 7
    s_add_u32 s90, s90, s4
    s_add_u32 s34, s90, 557056
    v_mfma_f32_32x32x16_bf16 v[128:143], a[4:7], v[20:23], v[128:143]
    ds_read_b64_tr_b16 a[38:39], v243 offset:37888
    ds_read_b64_tr_b16 a[40:41], v243 offset:40960
    s_mul_i32 s4, s36, 139264
    s_add_u32 s90, s90, s4
    v_mfma_f32_32x32x16_bf16 v[128:143], a[8:11], v[20:23], v[128:143]
    ds_read_b64_tr_b16 a[42:43], v243 offset:41984
    ds_read_b64_tr_b16 a[44:45], v243 offset:45056
    ds_read_b64_tr_b16 a[46:47], v243 offset:46080
    s_lshl_b32 s5, s67, 6
    v_lshl_add_u32 v25, v6, 3, s5
    v_and_b32 v10, 31, v1
    v_mfma_f32_32x32x16_bf16 v[128:143], a[12:15], v[20:23], v[128:143]
    ds_read_b64_tr_b16 a[48:49], v243 offset:49152
    ds_read_b64_tr_b16 a[50:51], v243 offset:50176
    v_lshlrev_b32 v10, 4, v10
    s_lshl_b32 s91, s66, 10
    v_mfma_f32_32x32x16_bf16 v[128:143], a[16:19], v[20:23], v[128:143]
    ds_read_b64_tr_b16 a[52:53], v243 offset:53248
    ds_read_b64_tr_b16 a[54:55], v243 offset:54272
    ds_read_b64_tr_b16 a[56:57], v243 offset:57344
    s_add_u32 s91, s91, 0xb60000
    s_add_u32 s92, s91, 16384
    s_mul_i32 s74, s66, 229376
    v_mfma_f32_32x32x16_bf16 v[128:143], a[20:23], v[20:23], v[128:143]
    ds_read_b64_tr_b16 a[58:59], v243 offset:58368
    ds_read_b64_tr_b16 a[60:61], v243 offset:61440
    s_lshl_b32 s5, s67, 11
    s_add_u32 s74, s74, s5
    s_add_u32 s74, s74, 0x440000
    s_add_u32 s75, s74, 114688
    s_lshl_b32 s93, s66, 11
    s_lshl_b32 s5, s7, 5
    s_add_u32 s93, s93, s5
    s_add_u32 s94, s93, 0xb88000
    s_add_u32 s93, s93, 0xb80000
    s_waitcnt vmcnt(2)
    s_mov_b32 s72, 0
    s_branch L_pA_c
L_pA:
    buffer_load_dword v254, v250, s[8:11], s85 offen sc1
    s_waitcnt vmcnt(0)
L_pA_c:
    s_add_u32 s72, s72, 1
    v_cmp_ne_u32 vcc, s28, v254
    s_cmp_gt_u32 s72, 262144
    s_cbranch_scc1 L_pA_x
    s_and_b64 exec, exec, vcc
    s_cbranch_execnz L_pA
L_pA_x:
    s_mov_b64 exec, -1
    v_mfma_f32_32x32x16_bf16 v[128:143], a[24:27], v[20:23], v[128:143]
    ds_read_b64_tr_b16 a[62:63], v243 offset:62464
    ds_read_b64_tr_b16 a[64:65], v244 offset:0
    ds_read_b64_tr_b16 a[66:67], v244 offset:1024
    s_add_u32 m0, s70, 0
    v_mfma_f32_32x32x16_bf16 v[128:143], a[28:31], v[20:23], v[128:143]
    ds_read_b64_tr_b16 a[68:69], v244 offset:4096
    ds_read_b64_tr_b16 a[70:71], v244 offset:5120
    buffer_load_dwordx4 v188, s[8:11], s90 offen offset:0 sc1 lds
    s_mov_b32 s24, s60
    s_and_b32 s25, s61, 0xffff
    s_waitcnt lgkmcnt(15)
    v_mfma_f32_32x32x16_bf16 v[128:143], a[32:35], v[20:23], v[128:143]
    ds_read_b64_tr_b16 a[72:73], v244 offset:8192
    ds_read_b64_tr_b16 a[74:75], v244 offset:9216
    ds_read_b64_tr_b16 a[76:77], v244 offset:12288
    buffer_load_dwordx4 v189, s[8:11], s90 offen offset:1024 sc1 lds
    s_mov_b32 s26, 0x200000
    s_mov_b32 s27, 0x20000
    v_mfma_f32_32x32x16_bf16 v[128:143], a[36:39], v[20:23], v[128:143]
    ds_read_b64_tr_b16 a[78:79], v244 offset:13312
    ds_read_b64_tr_b16 a[80:81], v244 offset:16384
    buffer_load_dwordx4 v190, s[8:11], s90 offen offset:2048 sc1 lds
    s_lshr_b32 s87, s30, 1
    s_lshl_b32 s87, s87, 3
    s_waitcnt lgkmcnt(15)
    v_mfma_f32_32x32x16_bf16 v[128:143], a[40:43], v[20:23], v[128:143]
    ds_read_b64_tr_b16 a[82:83], v244 offset:17408
    ds_read_b64_tr_b16 a[84:85], v244 offset:20480
    ds_read_b64_tr_b16 a[86:87], v244 offset:21504
    buffer_load_dwordx4 v191, s[8:11], s90 offen offset:3072 sc1 lds
    s_lshr_b32 s37, s31, 2
    s_add_u32 s87, s87, s37
    v_mfma_f32_32x32x16_bf16 v[128:143], a[44:47], v[20:23], v[128:143]
    ds_read_b64_tr_b16 a[88:89], v244 offset:24576
    ds_read_b64_tr_b16 a[90:91], v244 offset:25600
    s_add_u32 s90, s90, 139264
    s_cmp_ge_u32 s90, s34
    s_cselect_b32 s47, 557056, 0
    s_sub_u32 s90, s90, s47
    s_and_b32 s84, s30, 1
    s_lshl_b32 s84, s84, 2
    v_mfma_f32_32x32x16_bf16 v[128:143], a[48:51], v[20:23], v[128:143]
    ds_read_b64_tr_b16 a[92:93], v244 offset:28672
    ds_read_b64_tr_b16 a[94:95], v244 offset:29696
    ds_read_b64_tr_b16 a[96:97], v243 offset:0
    s_add_u32 m0, s70, 131072
    s_and_b32 s40, s31, 3
    s_add_u32 s84, s84, s40
    s_waitcnt lgkmcnt(15)
    v_mfma_f32_32x32x16_bf16 v[128:143], a[52:55], v[20:23], v[128:143]
    ds_read_b64_tr_b16 a[98:99], v243 offset:1024
    ds_read_b64_tr_b16 a[100:101], v243 offset:4096
    buffer_load_dwordx4 v188, s[8:11], s90 offen offset:0 sc1 lds
    s_lshl_b32 s69, s84, 1
    s_add_u32 s69, s69, s80
    v_mfma_f32_32x32x16_bf16 v[128:143], a[56:59], v[20:23], v[128:143]
    ds_read_b64_tr_b16 a[102:103], v243 offset:5120
    ds_read_b64_tr_b16 a[104:105], v243 offset:8192
    ds_read_b64_tr_b16 a[106:107], v243 offset:9216
    buffer_load_dwordx4 v189, s[8:11], s90 offen offset:1024 sc1 lds
    v_bfe_u32 v24, v1, 2, 3
    v_lshlrev_b32 v192, 10, v24
    v_mfma_f32_32x32x16_bf16 v[128:143], a[60:63], v[20:23], v[128:143]
    ds_read_b64_tr_b16 a[108:109], v243 offset:12288
    ds_read_b64_tr_b16 a[110:111], v243 offset:13312
    buffer_load_dwordx4 v190, s[8:11], s90 offen offset:2048 sc1 lds
    v_lshl_add_u32 v192, v6, 6, v192
    v_lshl_add_u32 v192, v7, 4, v192
    v_mfma_f32_32x32x16_bf16 v[128:143], a[64:67], v[20:23], v[128:143]
    ds_read_b64_tr_b16 a[112:113], v243 offset:16384
    ds_read_b64_tr_b16 a[114:115], v243 offset:17408
    ds_read_b64_tr_b16 a[116:117], v243 offset:20480
    buffer_load_dwordx4 v191, s[8:11], s90 offen offset:3072 sc1 lds
    v_add_u32 v193, 7168, v192
    v_add_u32 v194, 14336, v192
    s_waitcnt lgkmcnt(15)
    v_mfma_f32_32x32x16_bf16 v[128:143], a[68:71], v[20:23], v[128:143]
    ds_read_b64_tr_b16 a[118:119], v243 offset:21504
    ds_read_b64_tr_b16 a[120:121], v243 offset:24576
    s_add_u32 s90, s90, 139264
    s_cmp_ge_u32 s90, s34
    s_cselect_b32 s47, 557056, 0
    s_sub_u32 s90, s90, s47
    v_add_u32 v195, 21504, v192
    s_mul_i32 s95, s3, 458752
    v_mfma_f32_32x32x16_bf16 v[128:143], a[72:75], v[20:23], v[128:143]
    ds_read_b64_tr_b16 a[122:123], v243 offset:25600
    ds_read_b64_tr_b16 a[124:125], v243 offset:28672
    ds_read_b64_tr_b16 a[126:127], v243 offset:29696
    global_load_dwordx2 v[160:161], v25, s[54:55] offset:0
    s_lshl_b32 s40, s84, 7
    s_add_u32 s95, s95, s40
    v_mfma_f32_32x32x16_bf16 v[128:143], a[76:79], v[20:23], v[128:143]
    global_load_dwordx2 v[162:163], v25, s[54:55] offset:16
    s_cmp_eq_u32 s37, 7
    s_cselect_b32 s37, 0, s37
    s_add_u32 s32, s95, 458752
    v_mfma_f32_32x32x16_bf16 v[128:143], a[80:83], v[20:23], v[128:143]
    global_load_dwordx2 v[164:165], v25, s[54:55] offset:32
    s_waitcnt vmcnt(11)
    s_barrier
    s_cmp_lg_u32 s3, 0
    s_cbranch_scc1 L_nf1
    s_mov_b64 exec, 1
    buffer_store_dword v252, v253, s[8:11], s83 offen sc1
    s_cmp_lg_u32 s2, 0
    s_cbranch_scc1 L_noep1
    s_add_u32 s4, s6, 1
    v_mov_b32 v2, s4
    v_mov_b32 v9, 0xb58000
    buffer_store_dword v2, v9, s[8:11], 0 offen sc1
L_noep1:
    s_mov_b64 exec, -1
L_nf1:
    s_lshl_b32 s40, s37, 16
    s_add_u32 s95, s95, s40
    v_mfma_f32_32x32x16_bf16 v[128:143], a[84:87], v[20:23], v[128:143]
    global_load_dwordx2 v[166:167], v25, s[54:55] offset:48
    s_lshl_b32 s40, s80, 9
    s_add_u32 s40, s40, s89
    s_waitcnt lgkmcnt(15)
    v_mfma_f32_32x32x16_bf16 v[128:143], a[88:91], v[20:23], v[128:143]
    s_add_u32 s40, s40, 32768
    v_add_u32 v236, s40, v245
    v_mfma_f32_32x32x16_bf16 v[128:143], a[92:95], v[20:23], v[128:143]
    v_xor_b32 v237, 512, v236
    v_add_u32 v238, 0x10000, v236
    s_waitcnt lgkmcnt(14)
    v_mfma_f32_32x32x16_bf16 v[128:143], a[96:99], v[20:23], v[128:143]
    v_add_u32 v239, 0x10000, v237
    s_waitcnt lgkmcnt(12)
    v_mfma_f32_32x32x16_bf16 v[128:143], a[100:103], v[20:23], v[128:143]
    s_waitcnt lgkmcnt(10)
    v_mfma_f32_32x32x16_bf16 v[128:143], a[104:107], v[20:23], v[128:143]
    s_waitcnt lgkmcnt(8)
    v_mfma_f32_32x32x16_bf16 v[128:143], a[108:111], v[20:23], v[128:143]
    s_waitcnt lgkmcnt(6)
    v_mfma_f32_32x32x16_bf16 v[128:143], a[112:115], v[20:23], v[128:143]
    s_waitcnt lgkmcnt(4)
    v_mfma_f32_32x32x16_bf16 v[128:143], a[116:119], v[20:23], v[128:143]
    s_waitcnt lgkmcnt(2)
    v_mfma_f32_32x32x16_bf16 v[128:143], a[120:123], v[20:23], v[128:143]
    s_waitcnt lgkmcnt(0)
    v_mfma_f32_32x32x16_bf16 v[128:143], a[124:127], v[20:23], v[128:143]
    s_waitcnt vmcnt(8) lgkmcnt(0)
    s_barrier
    s_nop 0
    ds_read_b64_tr_b16 v[32:33], v16 offset:0
    ds_read_b64_tr_b16 v[34:35], v16 offset:512
    ds_read_b64_tr_b16 v[36:37], v17 offset:0
    ds_read_b64_tr_b16 v[38:39], v17 offset:512
    ds_read_b64_tr_b16 v[40:41], v16 offset:2048
    ds_read_b64_tr_b16 v[42:43], v16 offset:2560
    ds_read_b64_tr_b16 v[44:45], v17 offset:2048
    ds_read_b64_tr_b16 v[46:47], v17 offset:2560
    s_waitcnt lgkmcnt(6)
    v_mfma_f32_32x32x16_bf16 v[64:79], a[0:3], v[32:35], 0
    ds_read_b64_tr_b16 v[48:49], v16 offset:4096
    ds_read_b64_tr_b16 v[50:51], v16 offset:4608
    s_add_u32 m0, s70, 16384
    s_waitcnt lgkmcnt(6)
    v_mfma_f32_32x32x16_bf16 v[80:95], a[0:3], v[36:39], 0
    ds_read_b64_tr_b16 v[52:53], v17 offset:4096
    ds_read_b64_tr_b16 v[54:55], v17 offset:4608
    buffer_load_dwordx4 v188, s[8:11], s90 offen offset:0 sc1 lds
    s_waitcnt lgkmcnt(6)
    v_mfma_f32_32x32x16_bf16 v[64:79], a[4:7], v[40:43], v[64:79]
    ds_read_b64_tr_b16 v[56:57], v16 offset:6144
    ds_read_b64_tr_b16 v[58:59], v16 offset:6656
    buffer_load_dwordx4 v189, s[8:11], s90 offen offset:1024 sc1 lds
    s_waitcnt lgkmcnt(6)
    v_mfma_f32_32x32x16_bf16 v[80:95], a[4:7], v[44:47], v[80:95]
    ds_read_b64_tr_b16 v[60:61], v17 offset:6144
    ds_read_b64_tr_b16 v[62:63], v17 offset:6656
    buffer_load_dwordx4 v190, s[8:11], s90 offen offset:2048 sc1 lds
    s_waitcnt lgkmcnt(6)
    v_mfma_f32_32x32x16_bf16 v[64:79], a[8:11], v[48:51], v[64:79]
    ds_read_b64_tr_b16 v[32:33], v16 offset:8192
    ds_read_b64_tr_b16 v[34:35], v16 offset:8704
    buffer_load_dwordx4 v191, s[8:11], s90 offen offset:3072 sc1 lds
    s_lshr_b32 s40, s87, 1
    s_waitcnt lgkmcnt(6)
    v_mfma_f32_32x32x16_bf16 v[80:95], a[8:11], v[52:55], v[80:95]
    ds_read_b64_tr_b16 v[36:37], v17 offset:8192
    ds_read_b64_tr_b16 v[38:39], v17 offset:8704
    s_add_u32 s90, s90, 139264
    s_cmp_ge_u32 s90, s34
    s_cselect_b32 s47, 557056, 0
    s_sub_u32 s90, s90, s47
    s_lshl_b32 s40, s40, 11
    s_waitcnt lgkmcnt(6)
    v_mfma_f32_32x32x16_bf16 v[64:79], a[12:15], v[56:59], v[64:79]
    ds_read_b64_tr_b16 v[40:41], v16 offset:10240
    ds_read_b64_tr_b16 v[42:43], v16 offset:10752
    s_add_u32 m0, s70, 147456
    s_add_u32 s38, s40, 0xb80000
    s_waitcnt lgkmcnt(6)
    v_mfma_f32_32x32x16_bf16 v[80:95], a[12:15], v[60:63], v[80:95]
    ds_read_b64_tr_b16 v[44:45], v17 offset:10240
    ds_read_b64_tr_b16 v[46:47], v17 offset:10752
    buffer_load_dwordx4 v188, s[8:11], s90 offen offset:0 sc1 lds
    s_add_u32 s39, s40, 0xb88000
    s_waitcnt lgkmcnt(6)
    v_mfma_f32_32x32x16_bf16 v[64:79], a[16:19], v[32:35], v[64:79]
    ds_read_b64_tr_b16 v[48:49], v16 offset:12288
    ds_read_b64_tr_b16 v[50:51], v16 offset:12800
    buffer_load_dwordx4 v189, s[8:11], s90 offen offset:1024 sc1 lds
    v_lshlrev_b32 v245, 5, v1
    s_waitcnt lgkmcnt(6)
    v_mfma_f32_32x32x16_bf16 v[80:95], a[16:19], v[36:39], v[80:95]
    ds_read_b64_tr_b16 v[52:53], v17 offset:12288
    ds_read_b64_tr_b16 v[54:55], v17 offset:12800
    buffer_load_dwordx4 v190, s[8:11], s90 offen offset:2048 sc1 lds
    s_lshr_b32 s41, s3, 1
    s_waitcnt lgkmcnt(6)
    v_mfma_f32_32x32x16_bf16 v[64:79], a[20:23], v[40:43], v[64:79]
    ds_read_b64_tr_b16 v[56:57], v16 offset:14336
    ds_read_b64_tr_b16 v[58:59], v16 offset:14848
    buffer_load_dwordx4 v191, s[8:11], s90 offen offset:3072 sc1 lds
    s_lshl_b32 s40, s41, 8
    s_waitcnt lgkmcnt(6)
    v_mfma_f32_32x32x16_bf16 v[80:95], a[20:23], v[44:47], v[80:95]
    ds_read_b64_tr_b16 v[60:61], v17 offset:14336
    ds_read_b64_tr_b16 v[62:63], v17 offset:14848
    s_add_u32 s90, s90, 139264
    s_cmp_ge_u32 s90, s34
    s_cselect_b32 s47, 557056, 0
    s_sub_u32 s90, s90, s47
    v_xor_b32 v249, s40, v3
    s_waitcnt vmcnt(12)
    s_barrier
    s_waitcnt lgkmcnt(6)
    v_mfma_f32_32x32x16_bf16 v[64:79], a[24:27], v[48:51], v[64:79]
    ds_read_b64_tr_b16 v[32:33], v18 offset:0
    ds_read_b64_tr_b16 v[34:35], v18 offset:512
    s_add_u32 s90, s90, 2048
    s_add_u32 s34, s34, 2048
    s_mul_i32 s43, s87, 114688
    s_waitcnt lgkmcnt(6)
    v_mfma_f32_32x32x16_bf16 v[80:95], a[24:27], v[52:55], v[80:95]
    ds_read_b64_tr_b16 v[36:37], v19 offset:0
    ds_read_b64_tr_b16 v[38:39], v19 offset:512
    s_add_u32 m0, s89, 65536
    s_mul_i32 s40, s3, 28672
    s_waitcnt lgkmcnt(6)
    v_mfma_f32_32x32x16_bf16 v[64:79], a[28:31], v[56:59], v[64:79]
    ds_read_b64_tr_b16 v[40:41], v18 offset:2048
    ds_read_b64_tr_b16 v[42:43], v18 offset:2560
    buffer_load_dwordx4 v192, s[20:23], s95 offen offset:0  lds
    s_waitcnt vmcnt(9)
    v_lshlrev_b32 v144, 16, v160
    v_and_b32 v145, 0xffff0000, v160
    s_add_u32 s43, s43, s40
    s_waitcnt lgkmcnt(6)
    v_mfma_f32_32x32x16_bf16 v[80:95], a[28:31], v[60:63], v[80:95]
    ds_read_b64_tr_b16 v[44:45], v19 offset:2048
    ds_read_b64_tr_b16 v[46:47], v19 offset:2560
    buffer_load_dwordx4 v193, s[20:23], s95 offen offset:1024  lds
    v_lshlrev_b32 v146, 16, v161
    v_and_b32 v147, 0xffff0000, v161
    s_add_u32 s43, s43, 0x440000
    s_waitcnt lgkmcnt(6)
    v_mfma_f32_32x32x16_bf16 v[64:79], a[32:35], v[32:35], v[64:79]
    ds_read_b64_tr_b16 v[48:49], v18 offset:4096
    ds_read_b64_tr_b16 v[50:51], v18 offset:4608
    buffer_load_dwordx4 v194, s[20:23], s95 offen offset:2048  lds
    v_lshlrev_b32 v148, 16, v162
    v_and_b32 v149, 0xffff0000, v162
    s_add_u32 s35, s43, 28672
    s_waitcnt lgkmcnt(6)
    v_mfma_f32_32x32x16_bf16 v[80:95], a[32:35], v[36:39], v[80:95]
    ds_read_b64_tr_b16 v[52:53], v19 offset:4096
    ds_read_b64_tr_b16 v[54:55], v19 offset:4608
    buffer_load_dwordx4 v195, s[20:23], s95 offen offset:3072  lds
    v_lshlrev_b32 v150, 16, v163
    v_and_b32 v151, 0xffff0000, v163
    s_lshl_b32 s40, s37, 12
    s_waitcnt lgkmcnt(6)
    v_mfma_f32_32x32x16_bf16 v[64:79], a[36:39], v[40:43], v[64:79]
    ds_read_b64_tr_b16 v[56:57], v18 offset:6144
    ds_read_b64_tr_b16 v[58:59], v18 offset:6656
    s_add_u32 m0, m0, 4096
    v_lshlrev_b32 v152, 16, v164
    v_and_b32 v153, 0xffff0000, v164
    s_add_u32 s43, s43, s40
    s_waitcnt lgkmcnt(6)
    v_mfma_f32_32x32x16_bf16 v[80:95], a[36:39], v[44:47], v[80:95]
    ds_read_b64_tr_b16 v[60:61], v19 offset:6144
    ds_read_b64_tr_b16 v[62:63], v19 offset:6656
    s_add_u32 s95, s95, 32768
    v_lshlrev_b32 v154, 16, v165
    v_and_b32 v155, 0xffff0000, v165
    v_and_b32 v246, 31, v1
    s_waitcnt lgkmcnt(6)
    v_mfma_f32_32x32x16_bf16 v[64:79], a[40:43], v[48:51], v[64:79]
    ds_read_b64_tr_b16 v[32:33], v18 offset:8192
    ds_read_b64_tr_b16 v[34:35], v18 offset:8704
    buffer_load_dwordx4 v192, s[20:23], s95 offen offset:0  lds
    v_lshlrev_b32 v156, 16, v166
    v_and_b32 v157, 0xffff0000, v166
    s_lshl_b32 s40, s69, 5
    s_waitcnt lgkmcnt(6)
    v_mfma_f32_32x32x16_bf16 v[80:95], a[40:43], v[52:55], v[80:95]
    ds_read_b64_tr_b16 v[36:37], v19 offset:8192
    ds_read_b64_tr_b16 v[38:39], v19 offset:8704
    buffer_load_dwordx4 v193, s[20:23], s95 offen offset:1024  lds
    v_lshlrev_b32 v158, 16, v167
    v_and_b32 v159, 0xffff0000, v167
    v_add_u32 v246, s40, v246
    s_waitcnt lgkmcnt(6)
    v_mfma_f32_32x32x16_bf16 v[64:79], a[44:47], v[56:59], v[64:79]
    ds_read_b64_tr_b16 v[40:41], v18 offset:10240
    ds_read_b64_tr_b16 v[42:43], v18 offset:10752
    buffer_load_dwordx4 v194, s[20:23], s95 offen offset:2048  lds
    v_mul_u32_u24 v247, 4352, v246
    s_waitcnt lgkmcnt(6)
    v_mfma_f32_32x32x16_bf16 v[80:95], a[44:47], v[60:63], v[80:95]
    ds_read_b64_tr_b16 v[44:45], v19 offset:10240
    ds_read_b64_tr_b16 v[46:47], v19 offset:10752
    buffer_load_dwordx4 v195, s[20:23], s95 offen offset:3072  lds
    v_lshl_add_u32 v247, v6, 4, v247
    s_waitcnt lgkmcnt(6)
    v_mfma_f32_32x32x16_bf16 v[64:79], a[48:51], v[32:35], v[64:79]
    ds_read_b64_tr_b16 v[48:49], v18 offset:12288
    ds_read_b64_tr_b16 v[50:51], v18 offset:12800
    s_add_u32 s95, s95, 32768
    s_cmp_ge_u32 s95, s32
    s_cselect_b32 s47, 458752, 0
    s_sub_u32 s95, s95, s47
    s_lshl_b32 s44, s87, 6
    s_waitcnt lgkmcnt(6)
    v_mfma_f32_32x32x16_bf16 v[80:95], a[48:51], v[36:39], v[80:95]
    ds_read_b64_tr_b16 v[52:53], v19 offset:12288
    ds_read_b64_tr_b16 v[54:55], v19 offset:12800
    s_add_u32 m0, s89, 98304
    s_lshl_b32 s40, s41, 5
    s_waitcnt lgkmcnt(6)
    v_mfma_f32_32x32x16_bf16 v[64:79], a[52:55], v[40:43], v[64:79]
    ds_read_b64_tr_b16 v[56:57], v18 offset:14336
    ds_read_b64_tr_b16 v[58:59], v18 offset:14848
    buffer_load_dwordx4 v192, s[20:23], s95 offen offset:0  lds
    s_add_u32 s44, s44, s40
    s_waitcnt lgkmcnt(6)
    v_mfma_f32_32x32x16_bf16 v[80:95], a[52:55], v[44:47], v[80:95]
    ds_read_b64_tr_b16 v[60:61], v19 offset:14336
    ds_read_b64_tr_b16 v[62:63], v19 offset:14848
    buffer_load_dwordx4 v193, s[20:23], s95 offen offset:1024  lds
    s_add_u32 s44, s44, 0x220000
    s_waitcnt vmcnt(14)
    s_barrier
    s_waitcnt lgkmcnt(6)
    v_mfma_f32_32x32x16_bf16 v[64:79], a[56:59], v[48:51], v[64:79]
    ds_read_b64_tr_b16 v[32:33], v16 offset:16384
    ds_read_b64_tr_b16 v[34:35], v16 offset:16896
    buffer_load_dwordx4 v194, s[20:23], s95 offen offset:2048  lds
    v_lshlrev_b32 v246, 1, v246
    s_waitcnt lgkmcnt(6)
    v_mfma_f32_32x32x16_bf16 v[80:95], a[56:59], v[52:55], v[80:95]
    ds_read_b64_tr_b16 v[36:37], v17 offset:16384
    ds_read_b64_tr_b16 v[38:39], v17 offset:16896
    buffer_load_dwordx4 v195, s[20:23], s95 offen offset:3072  lds
    v_lshl_add_u32 v248, v6, 12, v246
    s_waitcnt lgkmcnt(6)
    v_mfma_f32_32x32x16_bf16 v[64:79], a[60:63], v[56:59], v[64:79]
    ds_read_b64_tr_b16 v[40:41], v16 offset:18432
    ds_read_b64_tr_b16 v[42:43], v16 offset:18944
    s_add_u32 m0, m0, 4096
    s_lshl_b32 s45, s87, 15
    s_waitcnt lgkmcnt(6)
    v_mfma_f32_32x32x16_bf16 v[80:95], a[60:63], v[60:63], v[80:95]
    ds_read_b64_tr_b16 v[44:45], v17 offset:18432
    ds_read_b64_tr_b16 v[46:47], v17 offset:18944
    s_add_u32 s95, s95, 32768
    s_lshl_b32 s40, s41, 14
    s_waitcnt lgkmcnt(6)
    v_mfma_f32_32x32x16_bf16 v[64:79], a[64:67], v[32:35], v[64:79]
    ds_read_b64_tr_b16 v[48:49], v16 offset:20480
    ds_read_b64_tr_b16 v[50:51], v16 offset:20992
    buffer_load_dwordx4 v192, s[20:23], s95 offen offset:0  lds
    s_add_u32 s45, s45, s40
    s_waitcnt lgkmcnt(6)
    v_mfma_f32_32x32x16_bf16 v[80:95], a[64:67], v[36:39], v[80:95]
    ds_read_b64_tr_b16 v[52:53], v17 offset:20480
    ds_read_b64_tr_b16 v[54:55], v17 offset:20992
    buffer_load_dwordx4 v193, s[20:23], s95 offen offset:1024  lds
    s_add_u32 s46, s45, 8192
    s_waitcnt lgkmcnt(6)
    v_mfma_f32_32x32x16_bf16 v[64:79], a[68:71], v[40:43], v[64:79]
    ds_read_b64_tr_b16 v[56:57], v16 offset:22528
    ds_read_b64_tr_b16 v[58:59], v16 offset:23040
    buffer_load_dwordx4 v194, s[20:23], s95 offen offset:2048  lds
    s_mul_i32 s40, s3, 6144
    s_waitcnt lgkmcnt(6)
    v_mfma_f32_32x32x16_bf16 v[80:95], a[68:71], v[44:47], v[80:95]
    ds_read_b64_tr_b16 v[60:61], v17 offset:22528
    ds_read_b64_tr_b16 v[62:63], v17 offset:23040
    buffer_load_dwordx4 v195, s[20:23], s95 offen offset:3072  lds
    v_add_u32 v12, s40, v3
    s_waitcnt lgkmcnt(6)
    v_mfma_f32_32x32x16_bf16 v[64:79], a[72:75], v[48:51], v[64:79]
    ds_read_b64_tr_b16 v[32:33], v16 offset:24576
    ds_read_b64_tr_b16 v[34:35], v16 offset:25088
    s_add_u32 s95, s95, 32768
    s_cmp_ge_u32 s95, s32
    s_cselect_b32 s47, 458752, 0
    s_sub_u32 s95, s95, s47
    s_xor_b32 s40, s3, 1
    s_waitcnt lgkmcnt(6)
    v_mfma_f32_32x32x16_bf16 v[80:95], a[72:75], v[52:55], v[80:95]
    ds_read_b64_tr_b16 v[36:37], v17 offset:24576
    ds_read_b64_tr_b16 v[38:39], v17 offset:25088
    s_add_u32 m0, s89, 32768
    s_mul_i32 s40, s40, 6144
    s_waitcnt lgkmcnt(6)
    v_mfma_f32_32x32x16_bf16 v[64:79], a[76:79], v[56:59], v[64:79]
    ds_read_b64_tr_b16 v[40:41], v16 offset:26624
    ds_read_b64_tr_b16 v[42:43], v16 offset:27136
    buffer_load_dwordx4 v192, s[20:23], s95 offen offset:0  lds
    s_add_u32 s40, s40, 0
    s_waitcnt lgkmcnt(6)
    v_mfma_f32_32x32x16_bf16 v[80:95], a[76:79], v[60:63], v[80:95]
    ds_read_b64_tr_b16 v[44:45], v17 offset:26624
    ds_read_b64_tr_b16 v[46:47], v17 offset:27136
    buffer_load_dwordx4 v193, s[20:23], s95 offen offset:1024  lds
    v_add_u32 v13, s40, v3
    s_waitcnt lgkmcnt(6)
    v_mfma_f32_32x32x16_bf16 v[64:79], a[80:83], v[32:35], v[64:79]
    ds_read_b64_tr_b16 v[48:49], v16 offset:28672
    ds_read_b64_tr_b16 v[50:51], v16 offset:29184
    buffer_load_dwordx4 v194, s[20:23], s95 offen offset:2048  lds
    s_xor_b32 s40, s3, 2
    s_waitcnt lgkmcnt(6)
    v_mfma_f32_32x32x16_bf16 v[80:95], a[80:83], v[36:39], v[80:95]
    ds_read_b64_tr_b16 v[52:53], v17 offset:28672
    ds_read_b64_tr_b16 v[54:55], v17 offset:29184
    buffer_load_dwordx4 v195, s[20:23], s95 offen offset:3072  lds
    s_mul_i32 s40, s40, 6144
    s_waitcnt lgkmcnt(6)
    v_mfma_f32_32x32x16_bf16 v[64:79], a[84:87], v[40:43], v[64:79]
    ds_read_b64_tr_b16 v[56:57], v16 offset:30720
    ds_read_b64_tr_b16 v[58:59], v16 offset:31232
    s_add_u32 m0, m0, 4096
    s_add_u32 s40, s40, 2048
    s_waitcnt lgkmcnt(6)
    v_mfma_f32_32x32x16_bf16 v[80:95], a[84:87], v[44:47], v[80:95]
    ds_read_b64_tr_b16 v[60:61], v17 offset:30720
    ds_read_b64_tr_b16 v[62:63], v17 offset:31232
    s_add_u32 s95, s95, 32768
    v_add_u32 v14, s40, v3
    s_waitcnt vmcnt(20)
    s_barrier
    s_waitcnt lgkmcnt(6)
    v_mfma_f32_32x32x16_bf16 v[64:79], a[88:91], v[48:51], v[64:79]
    ds_read_b64_tr_b16 v[32:33], v18 offset:16384
    ds_read_b64_tr_b16 v[34:35], v18 offset:16896
    buffer_load_dwordx4 v192, s[20:23], s95 offen offset:0  lds
    s_waitcnt vmcnt(13)
    ds_read_b64_tr_b16 a[128:129], v236 offset:32768
    ds_read_b64_tr_b16 a[130:131], v236 offset:33792
    ds_read_b64_tr_b16 a[132:133], v237 offset:32768
    s_xor_b32 s40, s3, 3
    s_waitcnt lgkmcnt(9)
    v_mfma_f32_32x32x16_bf16 v[80:95], a[88:91], v[52:55], v[80:95]
    ds_read_b64_tr_b16 v[36:37], v19 offset:16384
    ds_read_b64_tr_b16 v[38:39], v19 offset:16896
    buffer_load_dwordx4 v193, s[20:23], s95 offen offset:1024  lds
    ds_read_b64_tr_b16 a[134:135], v237 offset:33792
    ds_read_b64_tr_b16 a[136:137], v236 offset:34816
    s_mul_i32 s40, s40, 6144
    s_waitcnt lgkmcnt(11)
    v_mfma_f32_32x32x16_bf16 v[64:79], a[92:95], v[56:59], v[64:79]
    ds_read_b64_tr_b16 v[40:41], v18 offset:18432
    ds_read_b64_tr_b16 v[42:43], v18 offset:18944
    buffer_load_dwordx4 v194, s[20:23], s95 offen offset:2048  lds
    ds_read_b64_tr_b16 a[138:139], v236 offset:35840
    ds_read_b64_tr_b16 a[140:141], v237 offset:34816
    s_add_u32 s40, s40, 4096
    s_waitcnt lgkmcnt(13)
    v_mfma_f32_32x32x16_bf16 v[80:95], a[92:95], v[60:63], v[80:95]
    ds_read_b64_tr_b16 v[44:45], v19 offset:18432
    ds_read_b64_tr_b16 v[46:47], v19 offset:18944
    buffer_load_dwordx4 v195, s[20:23], s95 offen offset:3072  lds
    ds_read_b64_tr_b16 a[142:143], v237 offset:35840
    ds_read_b64_tr_b16 a[144:145], v236 offset:36864
    v_add_u32 v15, s40, v3
    s_waitcnt lgkmcnt(15)
    v_mfma_f32_32x32x16_bf16 v[64:79], a[96:99], v[32:35], v[64:79]
    ds_read_b64_tr_b16 v[48:49], v18 offset:20480
    ds_read_b64_tr_b16 v[50:51], v18 offset:20992
    buffer_load_dword v254, v250, s[8:11], s86 offen sc1
    s_add_u32 s95, s95, 32768
    s_cmp_ge_u32 s95, s32
    s_cselect_b32 s47, 458752, 0
    s_sub_u32 s95, s95, s47
    ds_read_b64_tr_b16 a[146:147], v236 offset:37888
    ds_read_b64_tr_b16 a[148:149], v237 offset:36864
    s_waitcnt lgkmcnt(14)
    v_mfma_f32_32x32x16_bf16 v[80:95], a[96:99], v[36:39], v[80:95]
    ds_read_b64_tr_b16 v[52:53], v19 offset:20480
    ds_read_b64_tr_b16 v[54:55], v19 offset:20992
    buffer_load_dwordx4 v[160:163], v10, s[8:11], s91 offen offset:0 sc1
    ds_read_b64_tr_b16 a[150:151], v237 offset:37888
    ds_read_b64_tr_b16 a[152:153], v236 offset:38912
    s_waitcnt lgkmcnt(14)
    v_mfma_f32_32x32x16_bf16 v[64:79], a[100:103], v[40:43], v[64:79]
    ds_read_b64_tr_b16 v[56:57], v18 offset:22528
    ds_read_b64_tr_b16 v[58:59], v18 offset:23040
    buffer_load_dwordx4 v[164:167], v10, s[8:11], s91 offen offset:512 sc1
    ds_read_b64_tr_b16 a[154:155], v236 offset:39936
    ds_read_b64_tr_b16 a[156:157], v237 offset:38912
    s_waitcnt lgkmcnt(14)
    v_mfma_f32_32x32x16_bf16 v[80:95], a[100:103], v[44:47], v[80:95]
    ds_read_b64_tr_b16 v[60:61], v19 offset:22528
    ds_read_b64_tr_b16 v[62:63], v19 offset:23040
    ds_read_b64_tr_b16 a[158:159], v237 offset:39936
    s_waitcnt lgkmcnt(13)
    v_mfma_f32_32x32x16_bf16 v[64:79], a[104:107], v[48:51], v[64:79]
    ds_read_b64_tr_b16 v[32:33], v18 offset:24576
    ds_read_b64_tr_b16 v[34:35], v18 offset:25088
    s_waitcnt lgkmcnt(11)
    v_mfma_f32_32x32x16_bf16 v[80:95], a[104:107], v[52:55], v[80:95]
    ds_read_b64_tr_b16 v[36:37], v19 offset:24576
    ds_read_b64_tr_b16 v[38:39], v19 offset:25088
    s_waitcnt lgkmcnt(9)
    v_mfma_f32_32x32x16_bf16 v[64:79], a[108:111], v[56:59], v[64:79]
    ds_read_b64_tr_b16 v[40:41], v18 offset:26624
    ds_read_b64_tr_b16 v[42:43], v18 offset:27136
    s_waitcnt lgkmcnt(7)
    v_mfma_f32_32x32x16_bf16 v[80:95], a[108:111], v[60:63], v[80:95]
    ds_read_b64_tr_b16 v[44:45], v19 offset:26624
    ds_read_b64_tr_b16 v[46:47], v19 offset:27136
    s_waitcnt lgkmcnt(6)
    v_mfma_f32_32x32x16_bf16 v[64:79], a[112:115], v[32:35], v[64:79]
    ds_read_b64_tr_b16 v[48:49], v18 offset:28672
    ds_read_b64_tr_b16 v[50:51], v18 offset:29184
    s_waitcnt lgkmcnt(6)
    v_mfma_f32_32x32x16_bf16 v[80:95], a[112:115], v[36:39], v[80:95]
    ds_read_b64_tr_b16 v[52:53], v19 offset:28672
    ds_read_b64_tr_b16 v[54:55], v19 offset:29184
    s_waitcnt lgkmcnt(6)
    v_mfma_f32_32x32x16_bf16 v[64:79], a[116:119], v[40:43], v[64:79]
    ds_read_b64_tr_b16 v[56:57], v18 offset:30720
    ds_read_b64_tr_b16 v[58:59], v18 offset:31232
    s_waitcnt lgkmcnt(6)
    v_mfma_f32_32x32x16_bf16 v[80:95], a[116:119], v[44:47], v[80:95]
    ds_read_b64_tr_b16 v[60:61], v19 offset:30720
    ds_read_b64_tr_b16 v[62:63], v19 offset:31232
    s_waitcnt lgkmcnt(6)
    v_mfma_f32_32x32x16_bf16 v[64:79], a[120:123], v[48:51], v[64:79]
    s_waitcnt lgkmcnt(4)
    v_mfma_f32_32x32x16_bf16 v[80:95], a[120:123], v[52:55], v[80:95]
    s_waitcnt lgkmcnt(2)
    v_mfma_f32_32x32x16_bf16 v[64:79], a[124:127], v[56:59], v[64:79]
    s_waitcnt lgkmcnt(0)
    v_mfma_f32_32x32x16_bf16 v[80:95], a[124:127], v[60:63], v[80:95]
    s_waitcnt vmcnt(2)
    s_mov_b32 s72, 0
    s_branch L_pB_c
L_pB:
    buffer_load_dword v254, v250, s[8:11], s86 offen sc1
    s_waitcnt vmcnt(0)
L_pB_c:
    s_add_u32 s72, s72, 1
    v_cmp_ne_u32 vcc, s28, v254
    s_cmp_gt_u32 s72, 262144
    s_cbranch_scc1 L_pB_x
    s_and_b64 exec, exec, vcc
    s_cbranch_execnz L_pB
L_pB_x:
    s_mov_b64 exec, -1
    s_add_u32 m0, s70, 0
    s_nop 0
    buffer_load_dwordx4 v188, s[8:11], s90 offen offset:0 sc1 lds
    buffer_load_dwordx4 v189, s[8:11], s90 offen offset:1024 sc1 lds
    buffer_load_dwordx4 v190, s[8:11], s90 offen offset:2048 sc1 lds
    buffer_load_dwordx4 v191, s[8:11], s90 offen offset:3072 sc1 lds
    s_add_u32 s90, s90, 139264
    s_cmp_ge_u32 s90, s34
    s_cselect_b32 s47, 557056, 0
    s_sub_u32 s90, s90, s47
    s_waitcnt vmcnt(4)
    s_mov_b32 s72, 0
    s_branch L_sA_c
L_sA:
    buffer_load_dwordx4 v[160:163], v10, s[8:11], s91 offen offset:0 sc1
    buffer_load_dwordx4 v[164:167], v10, s[8:11], s91 offen offset:512 sc1
    s_waitcnt vmcnt(0)
L_sA_c:
    s_add_u32 s72, s72, 1
    v_xor_b32 v2, s28, v162
    v_xor_b32 v9, s28, v166
    v_or_b32 v2, v2, v9
    v_cmp_ne_u32 vcc, 0, v2
    s_cmp_gt_u32 s72, 262144
    s_cbranch_scc1 L_sA_x
    s_cbranch_vccnz L_sA
L_sA_x:
    v_pk_fma_f32 v[64:65], v[64:65], v[160:161], v[144:145] op_sel:[0,1,0] op_sel_hi:[1,1,1]
    v_pk_fma_f32 v[66:67], v[66:67], v[160:161], v[146:147] op_sel:[0,1,0] op_sel_hi:[1,1,1]
    v_pk_fma_f32 v[68:69], v[68:69], v[160:161], v[148:149] op_sel:[0,1,0] op_sel_hi:[1,1,1]
    v_pk_fma_f32 v[70:71], v[70:71], v[160:161], v[150:151] op_sel:[0,1,0] op_sel_hi:[1,1,1]
    s_add_u32 m0, s70, 131072
    v_pk_fma_f32 v[64:65], v[128:129], v[160:161], v[64:65] op_sel_hi:[1,0,1]
    v_pk_fma_f32 v[66:67], v[130:131], v[160:161], v[66:67] op_sel_hi:[1,0,1]
    v_pk_fma_f32 v[68:69], v[132:133], v[160:161], v[68:69] op_sel_hi:[1,0,1]
    v_pk_fma_f32 v[70:71], v[134:135], v[160:161], v[70:71] op_sel_hi:[1,0,1]
    buffer_load_dwordx4 v188, s[8:11], s90 offen offset:0 sc1 lds
    v_max_f32 v64, 0, v64
    v_max_f32 v65, 0, v65
    v_max_f32 v66, 0, v66
    v_max_f32 v67, 0, v67
    buffer_load_dwordx4 v189, s[8:11], s90 offen offset:1024 sc1 lds
    v_max_f32 v68, 0, v68
    v_max_f32 v69, 0, v69
    v_max_f32 v70, 0, v70
    v_max_f32 v71, 0, v71
    buffer_load_dwordx4 v190, s[8:11], s90 offen offset:2048 sc1 lds
    v_pk_mul_f32 v[64:65], v[64:65], v[64:65]
    v_pk_mul_f32 v[66:67], v[66:67], v[66:67]
    v_pk_mul_f32 v[68:69], v[68:69], v[68:69]
    v_pk_mul_f32 v[70:71], v[70:71], v[70:71]
    buffer_load_dwordx4 v191, s[8:11], s90 offen offset:3072 sc1 lds
    v_cvt_pk_bf16_f32 v196, v64, v65
    v_cvt_pk_bf16_f32 v197, v66, v67
    v_cvt_pk_bf16_f32 v198, v68, v69
    v_cvt_pk_bf16_f32 v199, v70, v71
    s_add_u32 s90, s90, 139264
    s_cmp_ge_u32 s90, s34
    s_cselect_b32 s47, 557056, 0
    s_sub_u32 s90, s90, s47
    buffer_store_dwordx4 v[196:199], v3, s[8:11], s74 offen offset:0 sc1
    v_pk_fma_f32 v[72:73], v[72:73], v[160:161], v[152:153] op_sel:[0,1,0] op_sel_hi:[1,1,1]
    v_pk_fma_f32 v[74:75], v[74:75], v[160:161], v[154:155] op_sel:[0,1,0] op_sel_hi:[1,1,1]
    v_pk_fma_f32 v[76:77], v[76:77], v[160:161], v[156:157] op_sel:[0,1,0] op_sel_hi:[1,1,1]
    v_pk_fma_f32 v[78:79], v[78:79], v[160:161], v[158:159] op_sel:[0,1,0] op_sel_hi:[1,1,1]
    v_pk_fma_f32 v[72:73], v[136:137], v[160:161], v[72:73] op_sel_hi:[1,0,1]
    v_pk_fma_f32 v[74:75], v[138:139], v[160:161], v[74:75] op_sel_hi:[1,0,1]
    v_pk_fma_f32 v[76:77], v[140:141], v[160:161], v[76:77] op_sel_hi:[1,0,1]
    v_pk_fma_f32 v[78:79], v[142:143], v[160:161], v[78:79] op_sel_hi:[1,0,1]
    v_max_f32 v72, 0, v72
    v_max_f32 v73, 0, v73
    v_max_f32 v74, 0, v74
    v_max_f32 v75, 0, v75
    v_max_f32 v76, 0, v76
    v_max_f32 v77, 0, v77
    v_max_f32 v78, 0, v78
    v_max_f32 v79, 0, v79
    v_pk_mul_f32 v[72:73], v[72:73], v[72:73]
    v_pk_mul_f32 v[74:75], v[74:75], v[74:75]
    v_pk_mul_f32 v[76:77], v[76:77], v[76:77]
    v_pk_mul_f32 v[78:79], v[78:79], v[78:79]
    v_cvt_pk_bf16_f32 v200, v72, v73
    v_cvt_pk_bf16_f32 v201, v74, v75
    v_cvt_pk_bf16_f32 v202, v76, v77
    v_cvt_pk_bf16_f32 v203, v78, v79
    buffer_store_dwordx4 v[200:203], v3, s[8:11], s74 offen offset:1024 sc1
    v_pk_fma_f32 v[80:81], v[80:81], v[164:165], v[144:145] op_sel:[0,1,0] op_sel_hi:[1,1,1]
    v_pk_fma_f32 v[82:83], v[82:83], v[164:165], v[146:147] op_sel:[0,1,0] op_sel_hi:[1,1,1]
    v_pk_fma_f32 v[84:85], v[84:85], v[164:165], v[148:149] op_sel:[0,1,0] op_sel_hi:[1,1,1]
    v_pk_fma_f32 v[86:87], v[86:87], v[164:165], v[150:151] op_sel:[0,1,0] op_sel_hi:[1,1,1]
    v_pk_fma_f32 v[80:81], v[128:129], v[164:165], v[80:81] op_sel_hi:[1,0,1]
    v_pk_fma_f32 v[82:83], v[130:131], v[164:165], v[82:83] op_sel_hi:[1,0,1]
    v_pk_fma_f32 v[84:85], v[132:133], v[164:165], v[84:85] op_sel_hi:[1,0,1]
    v_pk_fma_f32 v[86:87], v[134:135], v[164:165], v[86:87] op_sel_hi:[1,0,1]
    v_max_f32 v80, 0, v80
    v_max_f32 v81, 0, v81
    v_max_f32 v82, 0, v82
    v_max_f32 v83, 0, v83
    v_max_f32 v84, 0, v84
    v_max_f32 v85, 0, v85
    v_max_f32 v86, 0, v86
    v_max_f32 v87, 0, v87
    v_pk_mul_f32 v[80:81], v[80:81], v[80:81]
    v_pk_mul_f32 v[82:83], v[82:83], v[82:83]
    v_pk_mul_f32 v[84:85], v[84:85], v[84:85]
    v_pk_mul_f32 v[86:87], v[86:87], v[86:87]
    v_cvt_pk_bf16_f32 v204, v80, v81
    v_cvt_pk_bf16_f32 v205, v82, v83
    v_cvt_pk_bf16_f32 v206, v84, v85
    v_cvt_pk_bf16_f32 v207, v86, v87
    buffer_store_dwordx4 v[204:207], v3, s[8:11], s75 offen offset:0 sc1
    v_pk_fma_f32 v[88:89], v[88:89], v[164:165], v[152:153] op_sel:[0,1,0] op_sel_hi:[1,1,1]
    v_pk_fma_f32 v[90:91], v[90:91], v[164:165], v[154:155] op_sel:[0,1,0] op_sel_hi:[1,1,1]
    v_pk_fma_f32 v[92:93], v[92:93], v[164:165], v[156:157] op_sel:[0,1,0] op_sel_hi:[1,1,1]
    v_pk_fma_f32 v[94:95], v[94:95], v[164:165], v[158:159] op_sel:[0,1,0] op_sel_hi:[1,1,1]
    v_pk_fma_f32 v[88:89], v[136:137], v[164:165], v[88:89] op_sel_hi:[1,0,1]
    v_pk_fma_f32 v[90:91], v[138:139], v[164:165], v[90:91] op_sel_hi:[1,0,1]
    v_pk_fma_f32 v[92:93], v[140:141], v[164:165], v[92:93] op_sel_hi:[1,0,1]
    v_pk_fma_f32 v[94:95], v[142:143], v[164:165], v[94:95] op_sel_hi:[1,0,1]
    v_max_f32 v88, 0, v88
    v_max_f32 v89, 0, v89
    v_max_f32 v90, 0, v90
    v_max_f32 v91, 0, v91
    v_max_f32 v92, 0, v92
    v_max_f32 v93, 0, v93
    v_max_f32 v94, 0, v94
    v_max_f32 v95, 0, v95
    v_pk_mul_f32 v[88:89], v[88:89], v[88:89]
    v_pk_mul_f32 v[90:91], v[90:91], v[90:91]
    v_pk_mul_f32 v[92:93], v[92:93], v[92:93]
    v_pk_mul_f32 v[94:95], v[94:95], v[94:95]
    v_cvt_pk_bf16_f32 v208, v88, v89
    v_cvt_pk_bf16_f32 v209, v90, v91
    v_cvt_pk_bf16_f32 v210, v92, v93
    v_cvt_pk_bf16_f32 v211, v94, v95
    buffer_store_dwordx4 v[208:211], v3, s[8:11], s75 offen offset:1024 sc1
    s_waitcnt vmcnt(8) lgkmcnt(0)
    s_barrier
    ds_read_b64_tr_b16 v[32:33], v16 offset:0
    ds_read_b64_tr_b16 v[34:35], v16 offset:512
    ds_read_b64_tr_b16 v[36:37], v17 offset:0
    ds_read_b64_tr_b16 v[38:39], v17 offset:512
    ds_read_b64_tr_b16 v[40:41], v16 offset:2048
    ds_read_b64_tr_b16 v[42:43], v16 offset:2560
    ds_read_b64_tr_b16 v[44:45], v17 offset:2048
    ds_read_b64_tr_b16 v[46:47], v17 offset:2560
    s_waitcnt lgkmcnt(6)
    v_mfma_f32_32x32x16_bf16 v[96:111], a[0:3], v[32:35], 0
    ds_read_b64_tr_b16 v[48:49], v16 offset:4096
    ds_read_b64_tr_b16 v[50:51], v16 offset:4608
    s_waitcnt vmcnt(23)
    ds_read_b64_tr_b16 a[160:161], v238 offset:0
    ds_read_b64_tr_b16 a[162:163], v238 offset:1024
    s_add_u32 m0, s70, 16384
    s_nop 0
    buffer_load_dwordx4 v188, s[8:11], s90 offen offset:0 sc1 lds
    s_waitcnt lgkmcnt(8)
    v_mfma_f32_32x32x16_bf16 v[112:127], a[0:3], v[36:39], 0
    ds_read_b64_tr_b16 v[52:53], v17 offset:4096
    ds_read_b64_tr_b16 v[54:55], v17 offset:4608
    ds_read_b64_tr_b16 a[164:165], v239 offset:0
    ds_read_b64_tr_b16 a[166:167], v239 offset:1024
    buffer_load_dwordx4 v189, s[8:11], s90 offen offset:1024 sc1 lds
    s_waitcnt lgkmcnt(10)
    v_mfma_f32_32x32x16_bf16 v[96:111], a[4:7], v[40:43], v[96:111]
    ds_read_b64_tr_b16 v[56:57], v16 offset:6144
    ds_read_b64_tr_b16 v[58:59], v16 offset:6656
    ds_read_b64_tr_b16 a[168:169], v238 offset:2048
    ds_read_b64_tr_b16 a[170:171], v238 offset:3072
    buffer_load_dwordx4 v190, s[8:11], s90 offen offset:2048 sc1 lds
    s_waitcnt lgkmcnt(12)
    v_mfma_f32_32x32x16_bf16 v[112:127], a[4:7], v[44:47], v[112:127]
    ds_read_b64_tr_b16 v[60:61], v17 offset:6144
    ds_read_b64_tr_b16 v[62:63], v17 offset:6656
    ds_read_b64_tr_b16 a[172:173], v239 offset:2048
    ds_read_b64_tr_b16 a[174:175], v239 offset:3072
    buffer_load_dwordx4 v191, s[8:11], s90 offen offset:3072 sc1 lds
    s_waitcnt lgkmcnt(14)
    v_mfma_f32_32x32x16_bf16 v[96:111], a[8:11], v[48:51], v[96:111]
    ds_read_b64_tr_b16 v[32:33], v16 offset:8192
    ds_read_b64_tr_b16 v[34:35], v16 offset:8704
    ds_read_b64_tr_b16 a[176:177], v238 offset:4096
    ds_read_b64_tr_b16 a[178:179], v238 offset:5120
    s_add_u32 s90, s90, 139264
    s_cmp_ge_u32 s90, s34
    s_cselect_b32 s47, 557056, 0
    s_sub_u32 s90, s90, s47
    s_waitcnt lgkmcnt(14)
    v_mfma_f32_32x32x16_bf16 v[112:127], a[8:11], v[52:55], v[112:127]
    ds_read_b64_tr_b16 v[36:37], v17 offset:8192
    ds_read_b64_tr_b16 v[38:39], v17 offset:8704
    ds_read_b64_tr_b16 a[180:181], v239 offset:4096
    ds_read_b64_tr_b16 a[182:183], v239 offset:5120
    s_add_u32 m0, s70, 147456
    s_waitcnt lgkmcnt(14)
    v_mfma_f32_32x32x16_bf16 v[96:111], a[12:15], v[56:59], v[96:111]
    ds_read_b64_tr_b16 v[40:41], v16 offset:10240
    ds_read_b64_tr_b16 v[42:43], v16 offset:10752
    ds_read_b64_tr_b16 a[184:185], v238 offset:6144
    ds_read_b64_tr_b16 a[186:187], v238 offset:7168
    buffer_load_dwordx4 v188, s[8:11], s90 offen offset:0 sc1 lds
    s_waitcnt lgkmcnt(14)
    v_mfma_f32_32x32x16_bf16 v[112:127], a[12:15], v[60:63], v[112:127]
    ds_read_b64_tr_b16 v[44:45], v17 offset:10240
    ds_read_b64_tr_b16 v[46:47], v17 offset:10752
    ds_read_b64_tr_b16 a[188:189], v239 offset:6144
    ds_read_b64_tr_b16 a[190:191], v239 offset:7168
    buffer_load_dwordx4 v189, s[8:11], s90 offen offset:1024 sc1 lds
    s_waitcnt lgkmcnt(14)
    v_mfma_f32_32x32x16_bf16 v[96:111], a[16:19], v[32:35], v[96:111]
    ds_read_b64_tr_b16 v[48:49], v16 offset:12288
    ds_read_b64_tr_b16 v[50:51], v16 offset:12800
    s_waitcnt vmcnt(20)
    ds_read_b64_tr_b16 a[192:193], v236 offset:0
    ds_read_b64_tr_b16 a[194:195], v236 offset:1024
    buffer_load_dwordx4 v190, s[8:11], s90 offen offset:2048 sc1 lds
    s_waitcnt lgkmcnt(14)
    v_mfma_f32_32x32x16_bf16 v[112:127], a[16:19], v[36:39], v[112:127]
    ds_read_b64_tr_b16 v[52:53], v17 offset:12288
    ds_read_b64_tr_b16 v[54:55], v17 offset:12800
    ds_read_b64_tr_b16 a[196:197], v237 offset:0
    ds_read_b64_tr_b16 a[198:199], v237 offset:1024
    buffer_load_dwordx4 v191, s[8:11], s90 offen offset:3072 sc1 lds
    s_waitcnt lgkmcnt(14)
    v_mfma_f32_32x32x16_bf16 v[96:111], a[20:23], v[40:43], v[96:111]
    ds_read_b64_tr_b16 v[56:57], v16 offset:14336
    ds_read_b64_tr_b16 v[58:59], v16 offset:14848
    ds_read_b64_tr_b16 a[200:201], v236 offset:2048
    ds_read_b64_tr_b16 a[202:203], v236 offset:3072
    s_add_u32 s90, s90, 139264
    s_cmp_ge_u32 s90, s34
    s_cselect_b32 s47, 557056, 0
    s_sub_u32 s90, s90, s47
    s_waitcnt lgkmcnt(14)
    v_mfma_f32_32x32x16_bf16 v[112:127], a[20:23], v[44:47], v[112:127]
    ds_read_b64_tr_b16 v[60:61], v17 offset:14336
    ds_read_b64_tr_b16 v[62:63], v17 offset:14848
    ds_read_b64_tr_b16 a[204:205], v237 offset:2048
    ds_read_b64_tr_b16 a[206:207], v237 offset:3072
    s_waitcnt vmcnt(12)
    s_barrier
    s_waitcnt lgkmcnt(14)
    v_mfma_f32_32x32x16_bf16 v[96:111], a[24:27], v[48:51], v[96:111]
    ds_read_b64_tr_b16 v[32:33], v18 offset:0
    ds_read_b64_tr_b16 v[34:35], v18 offset:512
    ds_read_b64_tr_b16 a[208:209], v236 offset:4096
    ds_read_b64_tr_b16 a[210:211], v236 offset:5120
    s_waitcnt lgkmcnt(14)
    v_mfma_f32_32x32x16_bf16 v[112:127], a[24:27], v[52:55], v[112:127]
    ds_read_b64_tr_b16 v[36:37], v19 offset:0
    ds_read_b64_tr_b16 v[38:39], v19 offset:512
    ds_read_b64_tr_b16 a[212:213], v237 offset:4096
    ds_read_b64_tr_b16 a[214:215], v237 offset:5120
    s_waitcnt lgkmcnt(14)
    v_mfma_f32_32x32x16_bf16 v[96:111], a[28:31], v[56:59], v[96:111]
    ds_read_b64_tr_b16 v[40:41], v18 offset:2048
    ds_read_b64_tr_b16 v[42:43], v18 offset:2560
    ds_read_b64_tr_b16 a[216:217], v236 offset:6144
    ds_read_b64_tr_b16 a[218:219], v236 offset:7168
    buffer_load_dwordx4 v[176:179], v247, s[8:11], s44 offen sc1
    global_load_ushort v251, v246, s[58:59]
    s_add_u32 m0, s89, 65536
    s_waitcnt lgkmcnt(14)
    v_mfma_f32_32x32x16_bf16 v[112:127], a[28:31], v[60:63], v[112:127]
    ds_read_b64_tr_b16 v[44:45], v19 offset:2048
    ds_read_b64_tr_b16 v[46:47], v19 offset:2560
    ds_read_b64_tr_b16 a[220:221], v237 offset:6144
    ds_read_b64_tr_b16 a[222:223], v237 offset:7168
    buffer_load_dwordx4 v192, s[20:23], s95 offen offset:0  lds
    s_waitcnt lgkmcnt(14)
    v_mfma_f32_32x32x16_bf16 v[96:111], a[32:35], v[32:35], v[96:111]
    ds_read_b64_tr_b16 v[48:49], v18 offset:4096
    ds_read_b64_tr_b16 v[50:51], v18 offset:4608
    buffer_load_dwordx4 v193, s[20:23], s95 offen offset:1024  lds
    s_waitcnt lgkmcnt(12)
    v_mfma_f32_32x32x16_bf16 v[112:127], a[32:35], v[36:39], v[112:127]
    ds_read_b64_tr_b16 v[52:53], v19 offset:4096
    ds_read_b64_tr_b16 v[54:55], v19 offset:4608
    buffer_load_dwordx4 v194, s[20:23], s95 offen offset:2048  lds
    s_waitcnt lgkmcnt(10)
    v_mfma_f32_32x32x16_bf16 v[96:111], a[36:39], v[40:43], v[96:111]
    ds_read_b64_tr_b16 v[56:57], v18 offset:6144
    ds_read_b64_tr_b16 v[58:59], v18 offset:6656
    s_waitcnt vmcnt(13)
    s_barrier
    s_cmp_lg_u32 s3, 0
    s_cbranch_scc1 L_nf2
    s_mov_b64 exec, 1
    buffer_store_dword v252, v253, s[8:11], s93 offen sc1
    s_mov_b64 exec, -1
L_nf2:
    buffer_load_dwordx4 v195, s[20:23], s95 offen offset:3072  lds
    s_waitcnt lgkmcnt(8)
    v_mfma_f32_32x32x16_bf16 v[112:127], a[36:39], v[44:47], v[112:127]
    ds_read_b64_tr_b16 v[60:61], v19 offset:6144
    ds_read_b64_tr_b16 v[62:63], v19 offset:6656
    s_add_u32 m0, m0, 4096
    s_waitcnt lgkmcnt(6)
    v_mfma_f32_32x32x16_bf16 v[96:111], a[40:43], v[48:51], v[96:111]
    ds_read_b64_tr_b16 v[32:33], v18 offset:8192
    ds_read_b64_tr_b16 v[34:35], v18 offset:8704
    s_add_u32 s95, s95, 32768
    s_waitcnt lgkmcnt(6)
    v_mfma_f32_32x32x16_bf16 v[112:127], a[40:43], v[52:55], v[112:127]
    ds_read_b64_tr_b16 v[36:37], v19 offset:8192
    ds_read_b64_tr_b16 v[38:39], v19 offset:8704
    buffer_load_dwordx4 v192, s[20:23], s95 offen offset:0  lds
    s_waitcnt lgkmcnt(6)
    v_mfma_f32_32x32x16_bf16 v[96:111], a[44:47], v[56:59], v[96:111]
    ds_read_b64_tr_b16 v[40:41], v18 offset:10240
    ds_read_b64_tr_b16 v[42:43], v18 offset:10752
    buffer_load_dwordx4 v193, s[20:23], s95 offen offset:1024  lds
    s_waitcnt lgkmcnt(6)
    v_mfma_f32_32x32x16_bf16 v[112:127], a[44:47], v[60:63], v[112:127]
    ds_read_b64_tr_b16 v[44:45], v19 offset:10240
    ds_read_b64_tr_b16 v[46:47], v19 offset:10752
    buffer_load_dwordx4 v194, s[20:23], s95 offen offset:2048  lds
    buffer_load_dwordx4 v195, s[20:23], s95 offen offset:3072  lds
    s_waitcnt lgkmcnt(6)
    v_mfma_f32_32x32x16_bf16 v[96:111], a[48:51], v[32:35], v[96:111]
    ds_read_b64_tr_b16 v[48:49], v18 offset:12288
    ds_read_b64_tr_b16 v[50:51], v18 offset:12800
    s_add_u32 s95, s95, 32768
    s_cmp_ge_u32 s95, s32
    s_cselect_b32 s47, 458752, 0
    s_sub_u32 s95, s95, s47
    s_waitcnt lgkmcnt(6)
    v_mfma_f32_32x32x16_bf16 v[112:127], a[48:51], v[36:39], v[112:127]
    ds_read_b64_tr_b16 v[52:53], v19 offset:12288
    ds_read_b64_tr_b16 v[54:55], v19 offset:12800
    s_add_u32 m0, s89, 98304
    s_waitcnt lgkmcnt(6)
    v_mfma_f32_32x32x16_bf16 v[96:111], a[52:55], v[40:43], v[96:111]
    ds_read_b64_tr_b16 v[56:57], v18 offset:14336
    ds_read_b64_tr_b16 v[58:59], v18 offset:14848
    buffer_load_dwordx4 v192, s[20:23], s95 offen offset:0  lds
    s_waitcnt lgkmcnt(6)
    v_mfma_f32_32x32x16_bf16 v[112:127], a[52:55], v[44:47], v[112:127]
    ds_read_b64_tr_b16 v[60:61], v19 offset:14336
    ds_read_b64_tr_b16 v[62:63], v19 offset:14848
    buffer_load_dwordx4 v193, s[20:23], s95 offen offset:1024  lds
    s_waitcnt vmcnt(16)
    s_barrier
    s_waitcnt lgkmcnt(6)
    v_mfma_f32_32x32x16_bf16 v[96:111], a[56:59], v[48:51], v[96:111]
    ds_read_b64_tr_b16 v[32:33], v16 offset:16384
    ds_read_b64_tr_b16 v[34:35], v16 offset:16896
    buffer_load_dwordx4 v194, s[20:23], s95 offen offset:2048  lds
    s_waitcnt lgkmcnt(6)
    v_mfma_f32_32x32x16_bf16 v[112:127], a[56:59], v[52:55], v[112:127]
    ds_read_b64_tr_b16 v[36:37], v17 offset:16384
    ds_read_b64_tr_b16 v[38:39], v17 offset:16896
    buffer_load_dwordx4 v195, s[20:23], s95 offen offset:3072  lds
    s_waitcnt lgkmcnt(6)
    v_mfma_f32_32x32x16_bf16 v[96:111], a[60:63], v[56:59], v[96:111]
    ds_read_b64_tr_b16 v[40:41], v16 offset:18432
    ds_read_b64_tr_b16 v[42:43], v16 offset:18944
    s_add_u32 m0, m0, 4096
    s_waitcnt lgkmcnt(6)
    v_mfma_f32_32x32x16_bf16 v[112:127], a[60:63], v[60:63], v[112:127]
    ds_read_b64_tr_b16 v[44:45], v17 offset:18432
    ds_read_b64_tr_b16 v[46:47], v17 offset:18944
    s_add_u32 s95, s95, 32768
    s_waitcnt lgkmcnt(6)
    v_mfma_f32_32x32x16_bf16 v[96:111], a[64:67], v[32:35], v[96:111]
    ds_read_b64_tr_b16 v[48:49], v16 offset:20480
    ds_read_b64_tr_b16 v[50:51], v16 offset:20992
    buffer_load_dwordx4 v192, s[20:23], s95 offen offset:0  lds
    s_waitcnt lgkmcnt(6)
    v_mfma_f32_32x32x16_bf16 v[112:127], a[64:67], v[36:39], v[112:127]
    ds_read_b64_tr_b16 v[52:53], v17 offset:20480
    ds_read_b64_tr_b16 v[54:55], v17 offset:20992
    buffer_load_dwordx4 v193, s[20:23], s95 offen offset:1024  lds
    buffer_load_dwordx4 v194, s[20:23], s95 offen offset:2048  lds
    s_waitcnt lgkmcnt(6)
    v_mfma_f32_32x32x16_bf16 v[96:111], a[68:71], v[40:43], v[96:111]
    ds_read_b64_tr_b16 v[56:57], v16 offset:22528
    ds_read_b64_tr_b16 v[58:59], v16 offset:23040
    buffer_load_dwordx4 v195, s[20:23], s95 offen offset:3072  lds
    s_waitcnt lgkmcnt(6)
    v_mfma_f32_32x32x16_bf16 v[112:127], a[68:71], v[44:47], v[112:127]
    ds_read_b64_tr_b16 v[60:61], v17 offset:22528
    ds_read_b64_tr_b16 v[62:63], v17 offset:23040
    s_add_u32 s95, s95, 32768
    s_cmp_ge_u32 s95, s32
    s_cselect_b32 s47, 458752, 0
    s_sub_u32 s95, s95, s47
    s_waitcnt lgkmcnt(6)
    v_mfma_f32_32x32x16_bf16 v[96:111], a[72:75], v[48:51], v[96:111]
    ds_read_b64_tr_b16 v[32:33], v16 offset:24576
    ds_read_b64_tr_b16 v[34:35], v16 offset:25088
    s_add_u32 m0, s89, 32768
    s_waitcnt lgkmcnt(6)
    v_mfma_f32_32x32x16_bf16 v[112:127], a[72:75], v[52:55], v[112:127]
    ds_read_b64_tr_b16 v[36:37], v17 offset:24576
    ds_read_b64_tr_b16 v[38:39], v17 offset:25088
    buffer_load_dwordx4 v192, s[20:23], s95 offen offset:0  lds
    s_waitcnt lgkmcnt(6)
    v_mfma_f32_32x32x16_bf16 v[96:111], a[76:79], v[56:59], v[96:111]
    ds_read_b64_tr_b16 v[40:41], v16 offset:26624
    ds_read_b64_tr_b16 v[42:43], v16 offset:27136
    s_waitcnt vmcnt(9)
    ds_read_b64_tr_b16 a[224:225], v236 offset:32768
    ds_read_b64_tr_b16 a[226:227], v236 offset:33792
    ds_read_b64_tr_b16 a[228:229], v237 offset:32768
    buffer_load_dwordx4 v193, s[20:23], s95 offen offset:1024  lds
    s_waitcnt lgkmcnt(9)
    v_mfma_f32_32x32x16_bf16 v[112:127], a[76:79], v[60:63], v[112:127]
    ds_read_b64_tr_b16 v[44:45], v17 offset:26624
    ds_read_b64_tr_b16 v[46:47], v17 offset:27136
    ds_read_b64_tr_b16 a[230:231], v237 offset:33792
    ds_read_b64_tr_b16 a[232:233], v236 offset:34816
    buffer_load_dwordx4 v194, s[20:23], s95 offen offset:2048  lds
    s_waitcnt lgkmcnt(11)
    v_mfma_f32_32x32x16_bf16 v[96:111], a[80:83], v[32:35], v[96:111]
    ds_read_b64_tr_b16 v[48:49], v16 offset:28672
    ds_read_b64_tr_b16 v[50:51], v16 offset:29184
    ds_read_b64_tr_b16 a[234:235], v236 offset:35840
    ds_read_b64_tr_b16 a[236:237], v237 offset:34816
    buffer_load_dwordx4 v195, s[20:23], s95 offen offset:3072  lds
    s_waitcnt lgkmcnt(13)
    v_mfma_f32_32x32x16_bf16 v[112:127], a[80:83], v[36:39], v[112:127]
    ds_read_b64_tr_b16 v[52:53], v17 offset:28672
    ds_read_b64_tr_b16 v[54:55], v17 offset:29184
    ds_read_b64_tr_b16 a[238:239], v237 offset:35840
    ds_read_b64_tr_b16 a[240:241], v236 offset:36864
    s_add_u32 m0, m0, 4096
    s_waitcnt lgkmcnt(15)
    v_mfma_f32_32x32x16_bf16 v[96:111], a[84:87], v[40:43], v[96:111]
    ds_read_b64_tr_b16 v[56:57], v16 offset:30720
    ds_read_b64_tr_b16 v[58:59], v16 offset:31232
    ds_read_b64_tr_b16 a[242:243], v236 offset:37888
    ds_read_b64_tr_b16 a[244:245], v237 offset:36864
    s_add_u32 s95, s95, 32768
    s_waitcnt lgkmcnt(14)
    v_mfma_f32_32x32x16_bf16 v[112:127], a[84:87], v[44:47], v[112:127]
    ds_read_b64_tr_b16 v[60:61], v17 offset:30720
    ds_read_b64_tr_b16 v[62:63], v17 offset:31232
    ds_read_b64_tr_b16 a[246:247], v237 offset:37888
    ds_read_b64_tr_b16 a[248:249], v236 offset:38912
    buffer_load_dwordx4 v192, s[20:23], s95 offen offset:0  lds
    buffer_load_dwordx4 v193, s[20:23], s95 offen offset:1024  lds
    s_waitcnt vmcnt(24)
    s_barrier
    s_waitcnt lgkmcnt(14)
    v_mfma_f32_32x32x16_bf16 v[96:111], a[88:91], v[48:51], v[96:111]
    ds_read_b64_tr_b16 v[32:33], v18 offset:16384
    ds_read_b64_tr_b16 v[34:35], v18 offset:16896
    ds_read_b64_tr_b16 a[250:251], v236 offset:39936
    ds_read_b64_tr_b16 a[252:253], v237 offset:38912
    buffer_load_dwordx4 v194, s[20:23], s95 offen offset:2048  lds
    s_waitcnt lgkmcnt(14)
    v_mfma_f32_32x32x16_bf16 v[112:127], a[88:91], v[52:55], v[112:127]
    ds_read_b64_tr_b16 v[36:37], v19 offset:16384
    ds_read_b64_tr_b16 v[38:39], v19 offset:16896
    ds_read_b64_tr_b16 a[254:255], v237 offset:39936
    buffer_load_dwordx4 v195, s[20:23], s95 offen offset:3072  lds
    s_waitcnt lgkmcnt(13)
    v_mfma_f32_32x32x16_bf16 v[96:111], a[92:95], v[56:59], v[96:111]
    ds_read_b64_tr_b16 v[40:41], v18 offset:18432
    ds_read_b64_tr_b16 v[42:43], v18 offset:18944
    s_add_u32 s95, s95, 32768
    s_cmp_ge_u32 s95, s32
    s_cselect_b32 s47, 458752, 0
    s_sub_u32 s95, s95, s47
    s_waitcnt lgkmcnt(11)
    v_mfma_f32_32x32x16_bf16 v[112:127], a[92:95], v[60:63], v[112:127]
    ds_read_b64_tr_b16 v[44:45], v19 offset:18432
    ds_read_b64_tr_b16 v[46:47], v19 offset:18944
    s_waitcnt lgkmcnt(9)
    v_mfma_f32_32x32x16_bf16 v[96:111], a[96:99], v[32:35], v[96:111]
    ds_read_b64_tr_b16 v[48:49], v18 offset:20480
    ds_read_b64_tr_b16 v[50:51], v18 offset:20992
    s_waitcnt lgkmcnt(7)
    v_mfma_f32_32x32x16_bf16 v[112:127], a[96:99], v[36:39], v[112:127]
    ds_read_b64_tr_b16 v[52:53], v19 offset:20480
    ds_read_b64_tr_b16 v[54:55], v19 offset:20992
    s_waitcnt lgkmcnt(6)
    v_mfma_f32_32x32x16_bf16 v[96:111], a[100:103], v[40:43], v[96:111]
    ds_read_b64_tr_b16 v[56:57], v18 offset:22528
    ds_read_b64_tr_b16 v[58:59], v18 offset:23040
    buffer_load_dwordx4 v[168:171], v10, s[8:11], s92 offen offset:0 sc1
    buffer_load_dwordx4 v[172:175], v10, s[8:11], s92 offen offset:512 sc1
    s_mov_b64 exec, 0x3fff
    buffer_load_dword v254, v245, s[8:11], s38 offen sc1
    s_mov_b64 exec, -1
    s_waitcnt lgkmcnt(6)
    v_mfma_f32_32x32x16_bf16 v[112:127], a[100:103], v[44:47], v[112:127]
    ds_read_b64_tr_b16 v[60:61], v19 offset:22528
    ds_read_b64_tr_b16 v[62:63], v19 offset:23040
    s_waitcnt lgkmcnt(6)
    v_mfma_f32_32x32x16_bf16 v[96:111], a[104:107], v[48:51], v[96:111]
    ds_read_b64_tr_b16 v[32:33], v18 offset:24576
    ds_read_b64_tr_b16 v[34:35], v18 offset:25088
    s_waitcnt lgkmcnt(6)
    v_mfma_f32_32x32x16_bf16 v[112:127], a[104:107], v[52:55], v[112:127]
    ds_read_b64_tr_b16 v[36:37], v19 offset:24576
    ds_read_b64_tr_b16 v[38:39], v19 offset:25088
    s_waitcnt lgkmcnt(6)
    v_mfma_f32_32x32x16_bf16 v[96:111], a[108:111], v[56:59], v[96:111]
    ds_read_b64_tr_b16 v[40:41], v18 offset:26624
    ds_read_b64_tr_b16 v[42:43], v18 offset:27136
    s_waitcnt lgkmcnt(6)
    v_mfma_f32_32x32x16_bf16 v[112:127], a[108:111], v[60:63], v[112:127]
    ds_read_b64_tr_b16 v[44:45], v19 offset:26624
    ds_read_b64_tr_b16 v[46:47], v19 offset:27136
    s_waitcnt lgkmcnt(6)
    v_mfma_f32_32x32x16_bf16 v[96:111], a[112:115], v[32:35], v[96:111]
    ds_read_b64_tr_b16 v[48:49], v18 offset:28672
    ds_read_b64_tr_b16 v[50:51], v18 offset:29184
    s_waitcnt lgkmcnt(6)
    v_mfma_f32_32x32x16_bf16 v[112:127], a[112:115], v[36:39], v[112:127]
    ds_read_b64_tr_b16 v[52:53], v19 offset:28672
    ds_read_b64_tr_b16 v[54:55], v19 offset:29184
    s_waitcnt lgkmcnt(6)
    v_mfma_f32_32x32x16_bf16 v[96:111], a[116:119], v[40:43], v[96:111]
    ds_read_b64_tr_b16 v[56:57], v18 offset:30720
    ds_read_b64_tr_b16 v[58:59], v18 offset:31232
    s_waitcnt lgkmcnt(6)
    v_mfma_f32_32x32x16_bf16 v[112:127], a[116:119], v[44:47], v[112:127]
    ds_read_b64_tr_b16 v[60:61], v19 offset:30720
    ds_read_b64_tr_b16 v[62:63], v19 offset:31232
    s_waitcnt lgkmcnt(6)
    v_mfma_f32_32x32x16_bf16 v[96:111], a[120:123], v[48:51], v[96:111]
    s_waitcnt lgkmcnt(4)
    v_mfma_f32_32x32x16_bf16 v[112:127], a[120:123], v[52:55], v[112:127]
    s_waitcnt lgkmcnt(2)
    v_mfma_f32_32x32x16_bf16 v[96:111], a[124:127], v[56:59], v[96:111]
    s_waitcnt lgkmcnt(0)
    v_mfma_f32_32x32x16_bf16 v[112:127], a[124:127], v[60:63], v[112:127]
    s_waitcnt vmcnt(1)
    s_mov_b32 s72, 0
    s_branch L_sB_c
L_sB:
    buffer_load_dwordx4 v[168:171], v10, s[8:11], s92 offen offset:0 sc1
    buffer_load_dwordx4 v[172:175], v10, s[8:11], s92 offen offset:512 sc1
    s_waitcnt vmcnt(0)
L_sB_c:
    s_add_u32 s72, s72, 1
    v_xor_b32 v2, s28, v170
    v_xor_b32 v9, s28, v174
    v_or_b32 v2, v2, v9
    v_cmp_ne_u32 vcc, 0, v2
    s_cmp_gt_u32 s72, 262144
    s_cbranch_scc1 L_sB_x
    s_cbranch_vccnz L_sB
L_sB_x:
    s_add_u32 s74, s74, 3670016
    s_add_u32 s75, s75, 3670016
    v_pk_fma_f32 v[96:97], v[96:97], v[168:169], v[144:145] op_sel:[0,1,0] op_sel_hi:[1,1,1]
    v_pk_fma_f32 v[98:99], v[98:99], v[168:169], v[146:147] op_sel:[0,1,0] op_sel_hi:[1,1,1]
    v_pk_fma_f32 v[100:101], v[100:101], v[168:169], v[148:149] op_sel:[0,1,0] op_sel_hi:[1,1,1]
    v_pk_fma_f32 v[102:103], v[102:103], v[168:169], v[150:151] op_sel:[0,1,0] op_sel_hi:[1,1,1]
    v_pk_fma_f32 v[96:97], v[128:129], v[168:169], v[96:97] op_sel_hi:[1,0,1]
    v_pk_fma_f32 v[98:99], v[130:131], v[168:169], v[98:99] op_sel_hi:[1,0,1]
    v_pk_fma_f32 v[100:101], v[132:133], v[168:169], v[100:101] op_sel_hi:[1,0,1]
    v_pk_fma_f32 v[102:103], v[134:135], v[168:169], v[102:103] op_sel_hi:[1,0,1]
    v_max_f32 v96, 0, v96
    v_max_f32 v97, 0, v97
    v_max_f32 v98, 0, v98
    v_max_f32 v99, 0, v99
    v_max_f32 v100, 0, v100
    v_max_f32 v101, 0, v101
    v_max_f32 v102, 0, v102
    v_max_f32 v103, 0, v103
    v_pk_mul_f32 v[96:97], v[96:97], v[96:97]
    v_pk_mul_f32 v[98:99], v[98:99], v[98:99]
    v_pk_mul_f32 v[100:101], v[100:101], v[100:101]
    v_pk_mul_f32 v[102:103], v[102:103], v[102:103]
    v_cvt_pk_bf16_f32 v16, v96, v97
    v_cvt_pk_bf16_f32 v17, v98, v99
    v_cvt_pk_bf16_f32 v18, v100, v101
    v_cvt_pk_bf16_f32 v19, v102, v103
    buffer_store_dwordx4 v[16:19], v3, s[8:11], s74 offen offset:0 sc1
    v_pk_fma_f32 v[104:105], v[104:105], v[168:169], v[152:153] op_sel:[0,1,0] op_sel_hi:[1,1,1]
    v_pk_fma_f32 v[106:107], v[106:107], v[168:169], v[154:155] op_sel:[0,1,0] op_sel_hi:[1,1,1]
    v_pk_fma_f32 v[108:109], v[108:109], v[168:169], v[156:157] op_sel:[0,1,0] op_sel_hi:[1,1,1]
    v_pk_fma_f32 v[110:111], v[110:111], v[168:169], v[158:159] op_sel:[0,1,0] op_sel_hi:[1,1,1]
    v_pk_fma_f32 v[104:105], v[136:137], v[168:169], v[104:105] op_sel_hi:[1,0,1]
    v_pk_fma_f32 v[106:107], v[138:139], v[168:169], v[106:107] op_sel_hi:[1,0,1]
    v_pk_fma_f32 v[108:109], v[140:141], v[168:169], v[108:109] op_sel_hi:[1,0,1]
    v_pk_fma_f32 v[110:111], v[142:143], v[168:169], v[110:111] op_sel_hi:[1,0,1]
    v_max_f32 v104, 0, v104
    v_max_f32 v105, 0, v105
    v_max_f32 v106, 0, v106
    v_max_f32 v107, 0, v107
    v_max_f32 v108, 0, v108
    v_max_f32 v109, 0, v109
    v_max_f32 v110, 0, v110
    v_max_f32 v111, 0, v111
    v_pk_mul_f32 v[104:105], v[104:105], v[104:105]
    v_pk_mul_f32 v[106:107], v[106:107], v[106:107]
    v_pk_mul_f32 v[108:109], v[108:109], v[108:109]
    v_pk_mul_f32 v[110:111], v[110:111], v[110:111]
    v_cvt_pk_bf16_f32 v20, v104, v105
    v_cvt_pk_bf16_f32 v21, v106, v107
    v_cvt_pk_bf16_f32 v22, v108, v109
    v_cvt_pk_bf16_f32 v23, v110, v111
    buffer_store_dwordx4 v[20:23], v3, s[8:11], s74 offen offset:1024 sc1
    v_pk_fma_f32 v[112:113], v[112:113], v[172:173], v[144:145] op_sel:[0,1,0] op_sel_hi:[1,1,1]
    v_pk_fma_f32 v[114:115], v[114:115], v[172:173], v[146:147] op_sel:[0,1,0] op_sel_hi:[1,1,1]
    v_pk_fma_f32 v[116:117], v[116:117], v[172:173], v[148:149] op_sel:[0,1,0] op_sel_hi:[1,1,1]
    v_pk_fma_f32 v[118:119], v[118:119], v[172:173], v[150:151] op_sel:[0,1,0] op_sel_hi:[1,1,1]
    v_pk_fma_f32 v[112:113], v[128:129], v[172:173], v[112:113] op_sel_hi:[1,0,1]
    v_pk_fma_f32 v[114:115], v[130:131], v[172:173], v[114:115] op_sel_hi:[1,0,1]
    v_pk_fma_f32 v[116:117], v[132:133], v[172:173], v[116:117] op_sel_hi:[1,0,1]
    v_pk_fma_f32 v[118:119], v[134:135], v[172:173], v[118:119] op_sel_hi:[1,0,1]
    v_max_f32 v112, 0, v112
    v_max_f32 v113, 0, v113
    v_max_f32 v114, 0, v114
    v_max_f32 v115, 0, v115
    v_max_f32 v116, 0, v116
    v_max_f32 v117, 0, v117
    v_max_f32 v118, 0, v118
    v_max_f32 v119, 0, v119
    v_pk_mul_f32 v[112:113], v[112:113], v[112:113]
    v_pk_mul_f32 v[114:115], v[114:115], v[114:115]
    v_pk_mul_f32 v[116:117], v[116:117], v[116:117]
    v_pk_mul_f32 v[118:119], v[118:119], v[118:119]
    v_cvt_pk_bf16_f32 v24, v112, v113
    v_cvt_pk_bf16_f32 v25, v114, v115
    v_cvt_pk_bf16_f32 v26, v116, v117
    v_cvt_pk_bf16_f32 v27, v118, v119
    buffer_store_dwordx4 v[24:27], v3, s[8:11], s75 offen offset:0 sc1
    v_pk_fma_f32 v[120:121], v[120:121], v[172:173], v[152:153] op_sel:[0,1,0] op_sel_hi:[1,1,1]
    v_pk_fma_f32 v[122:123], v[122:123], v[172:173], v[154:155] op_sel:[0,1,0] op_sel_hi:[1,1,1]
    v_pk_fma_f32 v[124:125], v[124:125], v[172:173], v[156:157] op_sel:[0,1,0] op_sel_hi:[1,1,1]
    v_pk_fma_f32 v[126:127], v[126:127], v[172:173], v[158:159] op_sel:[0,1,0] op_sel_hi:[1,1,1]
    v_pk_fma_f32 v[120:121], v[136:137], v[172:173], v[120:121] op_sel_hi:[1,0,1]
    v_pk_fma_f32 v[122:123], v[138:139], v[172:173], v[122:123] op_sel_hi:[1,0,1]
    v_pk_fma_f32 v[124:125], v[140:141], v[172:173], v[124:125] op_sel_hi:[1,0,1]
    v_pk_fma_f32 v[126:127], v[142:143], v[172:173], v[126:127] op_sel_hi:[1,0,1]
    v_max_f32 v120, 0, v120
    v_max_f32 v121, 0, v121
    v_max_f32 v122, 0, v122
    v_max_f32 v123, 0, v123
    v_max_f32 v124, 0, v124
    v_max_f32 v125, 0, v125
    v_max_f32 v126, 0, v126
    v_max_f32 v127, 0, v127
    v_pk_mul_f32 v[120:121], v[120:121], v[120:121]
    v_pk_mul_f32 v[122:123], v[122:123], v[122:123]
    v_pk_mul_f32 v[124:125], v[124:125], v[124:125]
    v_pk_mul_f32 v[126:127], v[126:127], v[126:127]
    v_cvt_pk_bf16_f32 v28, v120, v121
    v_cvt_pk_bf16_f32 v29, v122, v123
    v_cvt_pk_bf16_f32 v30, v124, v125
    v_cvt_pk_bf16_f32 v31, v126, v127
    buffer_store_dwordx4 v[28:31], v3, s[8:11], s75 offen offset:1024 sc1
    s_waitcnt vmcnt(4)
    s_mov_b64 exec, 0x3fff
    s_mov_b32 s72, 0
    s_branch L_pCA_c
L_pCA:
    buffer_load_dword v254, v245, s[8:11], s38 offen sc1
    s_waitcnt vmcnt(0)
L_pCA_c:
    s_add_u32 s72, s72, 1
    v_cmp_ne_u32 vcc, s28, v254
    s_cmp_gt_u32 s72, 262144
    s_cbranch_scc1 L_pCA_x
    s_and_b64 exec, exec, vcc
    s_cbranch_execnz L_pCA
L_pCA_x:
    s_mov_b64 exec, -1
    buffer_load_dwordx4 v[64:67], v249, s[8:11], s43 offen offset:0 sc1
    buffer_load_dwordx4 v[68:71], v249, s[8:11], s43 offen offset:1024 sc1
    buffer_load_dwordx4 v[72:75], v249, s[8:11], s43 offen offset:2048 sc1
    buffer_load_dwordx4 v[76:79], v249, s[8:11], s43 offen offset:3072 sc1
    s_add_u32 s43, s43, 4096
    s_cmp_ge_u32 s43, s35
    s_cselect_b32 s47, 28672, 0
    s_sub_u32 s43, s43, s47
    buffer_load_dwordx4 v[80:83], v249, s[8:11], s43 offen offset:0 sc1
    buffer_load_dwordx4 v[84:87], v249, s[8:11], s43 offen offset:1024 sc1
    buffer_load_dwordx4 v[88:91], v249, s[8:11], s43 offen offset:2048 sc1
    buffer_load_dwordx4 v[92:95], v249, s[8:11], s43 offen offset:3072 sc1
    s_add_u32 s43, s43, 4096
    s_cmp_ge_u32 s43, s35
    s_cselect_b32 s47, 28672, 0
    s_sub_u32 s43, s43, s47
    s_mov_b32 s81, s3
    s_branch L_join
L_sp:
    v_lshrrev_b32_e64 v9, 2, v1
    v_mul_u32_u24 v9, 4352, v9
    v_lshl_add_u32 v36, v7, 4, v9
    v_add_u32 v37, 68608, v36
    v_add_u32 v38, 137216, v36
    v_add_u32 v39, 205824, v36
    s_lshl_b32 s4, s30, 2
    s_add_u32 s4, s4, s31
    s_sub_u32 s4, s4, 28
    s_lshl_b32 s5, s4, 6
    s_add_u32 s90, s90, s5
    s_add_u32 m0, s89, 32768
    s_waitcnt vmcnt(2)
    s_mov_b32 s72, 0
    s_branch L_pA2_c
L_pA2:
    buffer_load_dword v254, v250, s[8:11], s85 offen sc1
    s_waitcnt vmcnt(0)
L_pA2_c:
    s_add_u32 s72, s72, 1
    v_cmp_ne_u32 vcc, s28, v254
    s_cmp_gt_u32 s72, 262144
    s_cbranch_scc1 L_pA2_x
    s_and_b64 exec, exec, vcc
    s_cbranch_execnz L_pA2
L_pA2_x:
    s_mov_b64 exec, -1
    s_nop 0
    buffer_load_dwordx4 v36, s[8:11], s90 offen offset:0 sc1 lds
    buffer_load_dwordx4 v37, s[8:11], s90 offen offset:1024 sc1 lds
    buffer_load_dwordx4 v38, s[8:11], s90 offen offset:2048 sc1 lds
    buffer_load_dwordx4 v39, s[8:11], s90 offen offset:3072 sc1 lds
    s_add_u32 m0, m0, 4096
    s_add_u32 s90, s90, 278528
    buffer_load_dwordx4 v36, s[8:11], s90 offen offset:0 sc1 lds
    buffer_load_dwordx4 v37, s[8:11], s90 offen offset:1024 sc1 lds
    buffer_load_dwordx4 v38, s[8:11], s90 offen offset:2048 sc1 lds
    buffer_load_dwordx4 v39, s[8:11], s90 offen offset:3072 sc1 lds
    s_add_u32 m0, m0, 4096
    s_add_u32 s90, s90, 278528
    v_lshl_add_u32 v11, v4, 3, v8
    v_lshlrev_b32 v11, 6, v11
    v_lshl_add_u32 v11, v7, 3, v11
    s_lshl_b32 s5, s80, 5
    v_add_u32 v11, s5, v11
    s_lshl_b32 s91, s4, 9
    s_lshl_b32 s5, s80, 8
    s_add_u32 s91, s91, s5
    s_add_u32 s91, s91, 0xb60000
    s_add_u32 s92, s91, 16384
    v_lshlrev_b32 v10, 4, v5
    v_cmp_eq_u32 s[74:75], 1, v7
    v_cmp_eq_u32 s[76:77], 2, v7
    v_cmp_eq_u32 s[78:79], 3, v7
    s_mov_b32 s24, s60
    s_and_b32 s25, s61, 0xffff
    s_mov_b32 s26, 0x200000
    s_mov_b32 s27, 0x20000
    s_lshr_b32 s87, s30, 1
    s_lshl_b32 s87, s87, 3
    s_lshr_b32 s37, s31, 2
    s_add_u32 s87, s87, s37
    s_and_b32 s84, s30, 1
    s_lshl_b32 s84, s84, 2
    s_and_b32 s40, s31, 3
    s_add_u32 s84, s84, s40
    s_lshl_b32 s69, s84, 1
    s_add_u32 s69, s69, s80
    v_bfe_u32 v24, v1, 2, 3
    v_lshlrev_b32_e64 v192, 10, v24
    v_lshl_add_u32 v192, v6, 6, v192
    v_lshl_add_u32 v192, v7, 4, v192
    v_add_u32 v193, 7168, v192
    v_add_u32 v194, 14336, v192
    v_add_u32 v195, 21504, v192
    s_mul_i32 s95, s3, 458752
    s_lshl_b32 s40, s84, 7
    s_add_u32 s95, s95, s40
    s_cmp_eq_u32 s37, 7
    s_cselect_b32 s37, 0, s37
    s_add_u32 s32, s95, 458752
    s_lshl_b32 s40, s37, 16
    s_add_u32 s95, s95, s40
    s_lshl_b32 s40, s80, 9
    s_add_u32 s40, s40, s89
    s_add_u32 s40, s40, 32768
    v_add_u32 v236, s40, v245
    v_xor_b32 v237, 512, v236
    v_add_u32 v238, 0x10000, v236
    v_add_u32 v239, 0x10000, v237
    s_waitcnt vmcnt(8)
    s_barrier
    s_cmp_lg_u32 s3, 0
    s_cbranch_scc1 L_nf3
    s_mov_b64 exec, 1
    buffer_store_dword v252, v253, s[8:11], s83 offen sc1
    s_mov_b64 exec, -1
L_nf3:
    s_waitcnt vmcnt(0)
    s_barrier
    s_nop 0
    ds_read_b64_tr_b16 v[64:65], v11 offset:32768
    ds_read_b64_tr_b16 v[66:67], v11 offset:33024
    ds_read_b64_tr_b16 v[68:69], v11 offset:34816
    ds_read_b64_tr_b16 v[70:71], v11 offset:35072
    ds_read_b64_tr_b16 v[72:73], v11 offset:36864
    ds_read_b64_tr_b16 v[74:75], v11 offset:37120
    ds_read_b64_tr_b16 v[76:77], v11 offset:38912
    ds_read_b64_tr_b16 v[78:79], v11 offset:39168
    ds_read_b64_tr_b16 v[80:81], v11 offset:40960
    ds_read_b64_tr_b16 v[82:83], v11 offset:41216
    ds_read_b64_tr_b16 v[84:85], v11 offset:43008
    ds_read_b64_tr_b16 v[86:87], v11 offset:43264
    ds_read_b64_tr_b16 v[88:89], v11 offset:45056
    ds_read_b64_tr_b16 v[90:91], v11 offset:45312
    s_waitcnt lgkmcnt(12)
    v_mfma_f32_16x16x32_bf16 v[24:27], v[64:67], v[64:67], 0
    v_mfma_f32_16x16x32_bf16 v[28:31], v[20:23], v[64:67], 0
    ds_read_b64_tr_b16 v[92:93], v11 offset:47104
    ds_read_b64_tr_b16 v[94:95], v11 offset:47360
    s_waitcnt lgkmcnt(12)
    v_mfma_f32_16x16x32_bf16 v[24:27], v[68:71], v[68:71], v[24:27]
    v_mfma_f32_16x16x32_bf16 v[28:31], v[20:23], v[68:71], v[28:31]
    ds_read_b64_tr_b16 v[96:97], v11 offset:49152
    ds_read_b64_tr_b16 v[98:99], v11 offset:49408
    s_waitcnt lgkmcnt(12)
    v_mfma_f32_16x16x32_bf16 v[24:27], v[72:75], v[72:75], v[24:27]
    v_mfma_f32_16x16x32_bf16 v[28:31], v[20:23], v[72:75], v[28:31]
    ds_read_b64_tr_b16 v[100:101], v11 offset:51200
    ds_read_b64_tr_b16 v[102:103], v11 offset:51456
    s_waitcnt lgkmcnt(12)
    v_mfma_f32_16x16x32_bf16 v[24:27], v[76:79], v[76:79], v[24:27]
    v_mfma_f32_16x16x32_bf16 v[28:31], v[20:23], v[76:79], v[28:31]
    ds_read_b64_tr_b16 v[104:105], v11 offset:53248
    ds_read_b64_tr_b16 v[106:107], v11 offset:53504
    s_waitcnt lgkmcnt(12)
    v_mfma_f32_16x16x32_bf16 v[24:27], v[80:83], v[80:83], v[24:27]
    v_mfma_f32_16x16x32_bf16 v[28:31], v[20:23], v[80:83], v[28:31]
    ds_read_b64_tr_b16 v[108:109], v11 offset:55296
    ds_read_b64_tr_b16 v[110:111], v11 offset:55552
    s_waitcnt lgkmcnt(12)
    v_mfma_f32_16x16x32_bf16 v[24:27], v[84:87], v[84:87], v[24:27]
    v_mfma_f32_16x16x32_bf16 v[28:31], v[20:23], v[84:87], v[28:31]
    ds_read_b64_tr_b16 v[112:113], v11 offset:57344
    ds_read_b64_tr_b16 v[114:115], v11 offset:57600
    s_waitcnt lgkmcnt(12)
    v_mfma_f32_16x16x32_bf16 v[24:27], v[88:91], v[88:91], v[24:27]
    v_mfma_f32_16x16x32_bf16 v[28:31], v[20:23], v[88:91], v[28:31]
    ds_read_b64_tr_b16 v[116:117], v11 offset:59392
    ds_read_b64_tr_b16 v[118:119], v11 offset:59648
    s_waitcnt lgkmcnt(12)
    v_mfma_f32_16x16x32_bf16 v[24:27], v[92:95], v[92:95], v[24:27]
    v_mfma_f32_16x16x32_bf16 v[28:31], v[20:23], v[92:95], v[28:31]
    ds_read_b64_tr_b16 v[120:121], v11 offset:61440
    ds_read_b64_tr_b16 v[122:123], v11 offset:61696
    s_waitcnt lgkmcnt(12)
    v_mfma_f32_16x16x32_bf16 v[24:27], v[96:99], v[96:99], v[24:27]
    v_mfma_f32_16x16x32_bf16 v[28:31], v[20:23], v[96:99], v[28:31]
    ds_read_b64_tr_b16 v[124:125], v11 offset:63488
    ds_read_b64_tr_b16 v[126:127], v11 offset:63744
    s_waitcnt lgkmcnt(12)
    v_mfma_f32_16x16x32_bf16 v[24:27], v[100:103], v[100:103], v[24:27]
    v_mfma_f32_16x16x32_bf16 v[28:31], v[20:23], v[100:103], v[28:31]
    s_waitcnt lgkmcnt(10)
    v_mfma_f32_16x16x32_bf16 v[24:27], v[104:107], v[104:107], v[24:27]
    v_mfma_f32_16x16x32_bf16 v[28:31], v[20:23], v[104:107], v[28:31]
    s_waitcnt lgkmcnt(8)
    v_mfma_f32_16x16x32_bf16 v[24:27], v[108:111], v[108:111], v[24:27]
    v_mfma_f32_16x16x32_bf16 v[28:31], v[20:23], v[108:111], v[28:31]
    s_waitcnt lgkmcnt(6)
    v_mfma_f32_16x16x32_bf16 v[24:27], v[112:115], v[112:115], v[24:27]
    v_mfma_f32_16x16x32_bf16 v[28:31], v[20:23], v[112:115], v[28:31]
    s_waitcnt lgkmcnt(4)
    v_mfma_f32_16x16x32_bf16 v[24:27], v[116:119], v[116:119], v[24:27]
    v_mfma_f32_16x16x32_bf16 v[28:31], v[20:23], v[116:119], v[28:31]
    s_waitcnt lgkmcnt(2)
    v_mfma_f32_16x16x32_bf16 v[24:27], v[120:123], v[120:123], v[24:27]
    v_mfma_f32_16x16x32_bf16 v[28:31], v[20:23], v[120:123], v[28:31]
    s_waitcnt lgkmcnt(0)
    v_mfma_f32_16x16x32_bf16 v[24:27], v[124:127], v[124:127], v[24:27]
    v_mfma_f32_16x16x32_bf16 v[28:31], v[20:23], v[124:127], v[28:31]
    s_nop 6
    v_cndmask_b32 v24, v24, v25, s[74:75]
    v_cndmask_b32 v24, v24, v26, s[76:77]
    v_cndmask_b32 v24, v24, v27, s[78:79]
    v_mul_f32 v28, 0x3b000000, v28
    v_mul_f32 v24, 0x3b000000, v24
    v_fma_f32 v24, -v28, v28, v24
    v_max_f32 v24, 0, v24
    v_cvt_pk_bf16_f32 v25, v28, v24
    v_lshlrev_b32_e64 v32, 16, v25
    v_and_b32 v25, 0xffff0000, v25
    v_add_f32 v25, 0x3727c5ac, v25
    v_cvt_pk_bf16_f32 v25, v25, v25
    v_and_b32 v25, 0xffff0000, v25
    v_sqrt_f32 v25, v25
    s_nop 0
    v_cvt_pk_bf16_f32 v25, v25, v25
    v_and_b32 v25, 0xffff0000, v25
    v_rcp_f32 v33, v25
    s_nop 0
    v_mul_f32 v32, -v32, v33
    v_mov_b32 v34, s28
    v_mov_b32 v35, s28
    s_cmp_ge_u32 s3, 2
    s_cbranch_scc1 L_sps0
    s_mov_b32 exec_lo, 0x00F0000F
    s_mov_b32 exec_hi, 0xF0000F00
    buffer_store_dwordx4 v[32:35], v10, s[8:11], s91 offen sc1
    s_mov_b64 exec, -1
L_sps0:
    buffer_load_dword v254, v250, s[8:11], s86 offen sc1
    s_waitcnt vmcnt(0)
    s_mov_b32 s72, 0
    s_branch L_pB2_c
L_pB2:
    buffer_load_dword v254, v250, s[8:11], s86 offen sc1
    s_waitcnt vmcnt(0)
L_pB2_c:
    s_add_u32 s72, s72, 1
    v_cmp_ne_u32 vcc, s28, v254
    s_cmp_gt_u32 s72, 262144
    s_cbranch_scc1 L_pB2_x
    s_and_b64 exec, exec, vcc
    s_cbranch_execnz L_pB2
L_pB2_x:
    s_mov_b64 exec, -1
    s_add_u32 s90, s90, -555008
    s_mov_b32 m0, s89
    s_nop 0
    s_nop 0
    buffer_load_dwordx4 v36, s[8:11], s90 offen offset:0 sc1 lds
    buffer_load_dwordx4 v37, s[8:11], s90 offen offset:1024 sc1 lds
    buffer_load_dwordx4 v38, s[8:11], s90 offen offset:2048 sc1 lds
    buffer_load_dwordx4 v39, s[8:11], s90 offen offset:3072 sc1 lds
    s_add_u32 m0, m0, 4096
    s_add_u32 s90, s90, 278528
    buffer_load_dwordx4 v36, s[8:11], s90 offen offset:0 sc1 lds
    buffer_load_dwordx4 v37, s[8:11], s90 offen offset:1024 sc1 lds
    buffer_load_dwordx4 v38, s[8:11], s90 offen offset:2048 sc1 lds
    buffer_load_dwordx4 v39, s[8:11], s90 offen offset:3072 sc1 lds
    s_add_u32 m0, m0, 4096
    s_add_u32 s90, s90, 278528
    s_add_u32 m0, s89, 65536
    s_nop 0
    s_nop 0
    buffer_load_dwordx4 v192, s[20:23], s95 offen offset:0  lds
    buffer_load_dwordx4 v193, s[20:23], s95 offen offset:1024  lds
    buffer_load_dwordx4 v194, s[20:23], s95 offen offset:2048  lds
    buffer_load_dwordx4 v195, s[20:23], s95 offen offset:3072  lds
    s_add_u32 m0, m0, 4096
    s_add_u32 s95, s95, 32768
    buffer_load_dwordx4 v192, s[20:23], s95 offen offset:0  lds
    buffer_load_dwordx4 v193, s[20:23], s95 offen offset:1024  lds
    buffer_load_dwordx4 v194, s[20:23], s95 offen offset:2048  lds
    buffer_load_dwordx4 v195, s[20:23], s95 offen offset:3072  lds
    s_add_u32 s95, s95, 32768
    s_cmp_ge_u32 s95, s32
    s_cselect_b32 s47, 458752, 0
    s_sub_u32 s95, s95, s47
    s_waitcnt vmcnt(8)
    s_barrier
    ds_read_b64_tr_b16 v[64:65], v11 offset:0
    ds_read_b64_tr_b16 v[66:67], v11 offset:256
    ds_read_b64_tr_b16 v[68:69], v11 offset:2048
    ds_read_b64_tr_b16 v[70:71], v11 offset:2304
    ds_read_b64_tr_b16 v[72:73], v11 offset:4096
    ds_read_b64_tr_b16 v[74:75], v11 offset:4352
    ds_read_b64_tr_b16 v[76:77], v11 offset:6144
    ds_read_b64_tr_b16 v[78:79], v11 offset:6400
    ds_read_b64_tr_b16 v[80:81], v11 offset:8192
    ds_read_b64_tr_b16 v[82:83], v11 offset:8448
    ds_read_b64_tr_b16 v[84:85], v11 offset:10240
    ds_read_b64_tr_b16 v[86:87], v11 offset:10496
    ds_read_b64_tr_b16 v[88:89], v11 offset:12288
    ds_read_b64_tr_b16 v[90:91], v11 offset:12544
    s_waitcnt lgkmcnt(12)
    v_mfma_f32_16x16x32_bf16 v[24:27], v[64:67], v[64:67], 0
    v_mfma_f32_16x16x32_bf16 v[28:31], v[20:23], v[64:67], 0
    ds_read_b64_tr_b16 v[92:93], v11 offset:14336
    ds_read_b64_tr_b16 v[94:95], v11 offset:14592
    s_waitcnt lgkmcnt(12)
    v_mfma_f32_16x16x32_bf16 v[24:27], v[68:71], v[68:71], v[24:27]
    v_mfma_f32_16x16x32_bf16 v[28:31], v[20:23], v[68:71], v[28:31]
    ds_read_b64_tr_b16 v[96:97], v11 offset:16384
    ds_read_b64_tr_b16 v[98:99], v11 offset:16640
    s_waitcnt lgkmcnt(12)
    v_mfma_f32_16x16x32_bf16 v[24:27], v[72:75], v[72:75], v[24:27]
    v_mfma_f32_16x16x32_bf16 v[28:31], v[20:23], v[72:75], v[28:31]
    ds_read_b64_tr_b16 v[100:101], v11 offset:18432
    ds_read_b64_tr_b16 v[102:103], v11 offset:18688
    s_waitcnt lgkmcnt(12)
    v_mfma_f32_16x16x32_bf16 v[24:27], v[76:79], v[76:79], v[24:27]
    v_mfma_f32_16x16x32_bf16 v[28:31], v[20:23], v[76:79], v[28:31]
    ds_read_b64_tr_b16 v[104:105], v11 offset:20480
    ds_read_b64_tr_b16 v[106:107], v11 offset:20736
    s_waitcnt lgkmcnt(12)
    v_mfma_f32_16x16x32_bf16 v[24:27], v[80:83], v[80:83], v[24:27]
    v_mfma_f32_16x16x32_bf16 v[28:31], v[20:23], v[80:83], v[28:31]
    ds_read_b64_tr_b16 v[108:109], v11 offset:22528
    ds_read_b64_tr_b16 v[110:111], v11 offset:22784
    s_waitcnt lgkmcnt(12)
    v_mfma_f32_16x16x32_bf16 v[24:27], v[84:87], v[84:87], v[24:27]
    v_mfma_f32_16x16x32_bf16 v[28:31], v[20:23], v[84:87], v[28:31]
    ds_read_b64_tr_b16 v[112:113], v11 offset:24576
    ds_read_b64_tr_b16 v[114:115], v11 offset:24832
    s_waitcnt lgkmcnt(12)
    v_mfma_f32_16x16x32_bf16 v[24:27], v[88:91], v[88:91], v[24:27]
    v_mfma_f32_16x16x32_bf16 v[28:31], v[20:23], v[88:91], v[28:31]
    ds_read_b64_tr_b16 v[116:117], v11 offset:26624
    ds_read_b64_tr_b16 v[118:119], v11 offset:26880
    s_waitcnt lgkmcnt(12)
    v_mfma_f32_16x16x32_bf16 v[24:27], v[92:95], v[92:95], v[24:27]
    v_mfma_f32_16x16x32_bf16 v[28:31], v[20:23], v[92:95], v[28:31]
    ds_read_b64_tr_b16 v[120:121], v11 offset:28672
    ds_read_b64_tr_b16 v[122:123], v11 offset:28928
    s_waitcnt lgkmcnt(12)
    v_mfma_f32_16x16x32_bf16 v[24:27], v[96:99], v[96:99], v[24:27]
    v_mfma_f32_16x16x32_bf16 v[28:31], v[20:23], v[96:99], v[28:31]
    ds_read_b64_tr_b16 v[124:125], v11 offset:30720
    ds_read_b64_tr_b16 v[126:127], v11 offset:30976
    s_waitcnt lgkmcnt(12)
    v_mfma_f32_16x16x32_bf16 v[24:27], v[100:103], v[100:103], v[24:27]
    v_mfma_f32_16x16x32_bf16 v[28:31], v[20:23], v[100:103], v[28:31]
    s_waitcnt lgkmcnt(10)
    v_mfma_f32_16x16x32_bf16 v[24:27], v[104:107], v[104:107], v[24:27]
    v_mfma_f32_16x16x32_bf16 v[28:31], v[20:23], v[104:107], v[28:31]
    s_waitcnt lgkmcnt(8)
    v_mfma_f32_16x16x32_bf16 v[24:27], v[108:111], v[108:111], v[24:27]
    v_mfma_f32_16x16x32_bf16 v[28:31], v[20:23], v[108:111], v[28:31]
    s_waitcnt lgkmcnt(6)
    v_mfma_f32_16x16x32_bf16 v[24:27], v[112:115], v[112:115], v[24:27]
    v_mfma_f32_16x16x32_bf16 v[28:31], v[20:23], v[112:115], v[28:31]
    s_waitcnt lgkmcnt(4)
    v_mfma_f32_16x16x32_bf16 v[24:27], v[116:119], v[116:119], v[24:27]
    v_mfma_f32_16x16x32_bf16 v[28:31], v[20:23], v[116:119], v[28:31]
    s_waitcnt lgkmcnt(2)
    v_mfma_f32_16x16x32_bf16 v[24:27], v[120:123], v[120:123], v[24:27]
    v_mfma_f32_16x16x32_bf16 v[28:31], v[20:23], v[120:123], v[28:31]
    s_waitcnt lgkmcnt(0)
    v_mfma_f32_16x16x32_bf16 v[24:27], v[124:127], v[124:127], v[24:27]
    v_mfma_f32_16x16x32_bf16 v[28:31], v[20:23], v[124:127], v[28:31]
    s_nop 6
    v_cndmask_b32 v24, v24, v25, s[74:75]
    v_cndmask_b32 v24, v24, v26, s[76:77]
    v_cndmask_b32 v24, v24, v27, s[78:79]
    v_mul_f32 v28, 0x3b000000, v28
    v_mul_f32 v24, 0x3b000000, v24
    v_fma_f32 v24, -v28, v28, v24
    v_max_f32 v24, 0, v24
    v_cvt_pk_bf16_f32 v25, v28, v24
    v_lshlrev_b32_e64 v32, 16, v25
    v_and_b32 v25, 0xffff0000, v25
    v_add_f32 v25, 0x3727c5ac, v25
    v_cvt_pk_bf16_f32 v25, v25, v25
    v_and_b32 v25, 0xffff0000, v25
    v_sqrt_f32 v25, v25
    s_nop 0
    v_cvt_pk_bf16_f32 v25, v25, v25
    v_and_b32 v25, 0xffff0000, v25
    v_rcp_f32 v33, v25
    s_nop 0
    v_mul_f32 v32, -v32, v33
    v_mov_b32 v34, s28
    v_mov_b32 v35, s28
    s_cmp_ge_u32 s3, 2
    s_cbranch_scc1 L_sps1
    s_mov_b32 exec_lo, 0x00F0000F
    s_mov_b32 exec_hi, 0xF0000F00
    buffer_store_dwordx4 v[32:35], v10, s[8:11], s92 offen sc1
    s_mov_b64 exec, -1
L_sps1:
    s_add_u32 m0, s89, 98304
    s_nop 0
    buffer_load_dwordx4 v192, s[20:23], s95 offen offset:0  lds
    buffer_load_dwordx4 v193, s[20:23], s95 offen offset:1024  lds
    buffer_load_dwordx4 v194, s[20:23], s95 offen offset:2048  lds
    buffer_load_dwordx4 v195, s[20:23], s95 offen offset:3072  lds
    s_add_u32 m0, m0, 4096
    s_add_u32 s95, s95, 32768
    buffer_load_dwordx4 v192, s[20:23], s95 offen offset:0  lds
    buffer_load_dwordx4 v193, s[20:23], s95 offen offset:1024  lds
    buffer_load_dwordx4 v194, s[20:23], s95 offen offset:2048  lds
    buffer_load_dwordx4 v195, s[20:23], s95 offen offset:3072  lds
    s_add_u32 s95, s95, 32768
    s_cmp_ge_u32 s95, s32
    s_cselect_b32 s47, 458752, 0
    s_sub_u32 s95, s95, s47
    s_add_u32 m0, s89, 32768
    s_nop 0
    s_nop 0
    buffer_load_dwordx4 v192, s[20:23], s95 offen offset:0  lds
    buffer_load_dwordx4 v193, s[20:23], s95 offen offset:1024  lds
    buffer_load_dwordx4 v194, s[20:23], s95 offen offset:2048  lds
    buffer_load_dwordx4 v195, s[20:23], s95 offen offset:3072  lds
    s_add_u32 m0, m0, 4096
    s_add_u32 s95, s95, 32768
    buffer_load_dwordx4 v192, s[20:23], s95 offen offset:0  lds
    buffer_load_dwordx4 v193, s[20:23], s95 offen offset:1024  lds
    buffer_load_dwordx4 v194, s[20:23], s95 offen offset:2048  lds
    buffer_load_dwordx4 v195, s[20:23], s95 offen offset:3072  lds
    s_add_u32 s95, s95, 32768
    s_cmp_ge_u32 s95, s32
    s_cselect_b32 s47, 458752, 0
    s_sub_u32 s95, s95, s47
    s_waitcnt vmcnt(16)
    s_nop 0
    ds_read_b64_tr_b16 a[128:129], v236 offset:32768
    ds_read_b64_tr_b16 a[130:131], v236 offset:33792
    ds_read_b64_tr_b16 a[132:133], v237 offset:32768
    ds_read_b64_tr_b16 a[134:135], v237 offset:33792
    ds_read_b64_tr_b16 a[136:137], v236 offset:34816
    ds_read_b64_tr_b16 a[138:139], v236 offset:35840
    ds_read_b64_tr_b16 a[140:141], v237 offset:34816
    ds_read_b64_tr_b16 a[142:143], v237 offset:35840
    ds_read_b64_tr_b16 a[144:145], v236 offset:36864
    ds_read_b64_tr_b16 a[146:147], v236 offset:37888
    ds_read_b64_tr_b16 a[148:149], v237 offset:36864
    ds_read_b64_tr_b16 a[150:151], v237 offset:37888
    ds_read_b64_tr_b16 a[152:153], v236 offset:38912
    ds_read_b64_tr_b16 a[154:155], v236 offset:39936
    ds_read_b64_tr_b16 a[156:157], v237 offset:38912
    ds_read_b64_tr_b16 a[158:159], v237 offset:39936
    s_waitcnt lgkmcnt(0)
    s_add_u32 m0, s89, 65536
    s_nop 0
    buffer_load_dwordx4 v192, s[20:23], s95 offen offset:0  lds
    buffer_load_dwordx4 v193, s[20:23], s95 offen offset:1024  lds
    buffer_load_dwordx4 v194, s[20:23], s95 offen offset:2048  lds
    buffer_load_dwordx4 v195, s[20:23], s95 offen offset:3072  lds
    s_add_u32 m0, m0, 4096
    s_add_u32 s95, s95, 32768
    buffer_load_dwordx4 v192, s[20:23], s95 offen offset:0  lds
    buffer_load_dwordx4 v193, s[20:23], s95 offen offset:1024  lds
    buffer_load_dwordx4 v194, s[20:23], s95 offen offset:2048  lds
    buffer_load_dwordx4 v195, s[20:23], s95 offen offset:3072  lds
    s_add_u32 s95, s95, 32768
    s_cmp_ge_u32 s95, s32
    s_cselect_b32 s47, 458752, 0
    s_sub_u32 s95, s95, s47
    s_waitcnt vmcnt(0)
    s_nop 0
    ds_read_b64_tr_b16 a[160:161], v238 offset:0
    ds_read_b64_tr_b16 a[162:163], v238 offset:1024
    ds_read_b64_tr_b16 a[164:165], v239 offset:0
    ds_read_b64_tr_b16 a[166:167], v239 offset:1024
    ds_read_b64_tr_b16 a[168:169], v238 offset:2048
    ds_read_b64_tr_b16 a[170:171], v238 offset:3072
    ds_read_b64_tr_b16 a[172:173], v239 offset:2048
    ds_read_b64_tr_b16 a[174:175], v239 offset:3072
    ds_read_b64_tr_b16 a[176:177], v238 offset:4096
    ds_read_b64_tr_b16 a[178:179], v238 offset:5120
    ds_read_b64_tr_b16 a[180:181], v239 offset:4096
    ds_read_b64_tr_b16 a[182:183], v239 offset:5120
    ds_read_b64_tr_b16 a[184:185], v238 offset:6144
    ds_read_b64_tr_b16 a[186:187], v238 offset:7168
    ds_read_b64_tr_b16 a[188:189], v239 offset:6144
    ds_read_b64_tr_b16 a[190:191], v239 offset:7168
    ds_read_b64_tr_b16 a[192:193], v236 offset:0
    ds_read_b64_tr_b16 a[194:195], v236 offset:1024
    ds_read_b64_tr_b16 a[196:197], v237 offset:0
    ds_read_b64_tr_b16 a[198:199], v237 offset:1024
    ds_read_b64_tr_b16 a[200:201], v236 offset:2048
    ds_read_b64_tr_b16 a[202:203], v236 offset:3072
    ds_read_b64_tr_b16 a[204:205], v237 offset:2048
    ds_read_b64_tr_b16 a[206:207], v237 offset:3072
    ds_read_b64_tr_b16 a[208:209], v236 offset:4096
    ds_read_b64_tr_b16 a[210:211], v236 offset:5120
    ds_read_b64_tr_b16 a[212:213], v237 offset:4096
    ds_read_b64_tr_b16 a[214:215], v237 offset:5120
    ds_read_b64_tr_b16 a[216:217], v236 offset:6144
    ds_read_b64_tr_b16 a[218:219], v236 offset:7168
    ds_read_b64_tr_b16 a[220:221], v237 offset:6144
    ds_read_b64_tr_b16 a[222:223], v237 offset:7168
    ds_read_b64_tr_b16 a[224:225], v236 offset:32768
    ds_read_b64_tr_b16 a[226:227], v236 offset:33792
    ds_read_b64_tr_b16 a[228:229], v237 offset:32768
    ds_read_b64_tr_b16 a[230:231], v237 offset:33792
    ds_read_b64_tr_b16 a[232:233], v236 offset:34816
    ds_read_b64_tr_b16 a[234:235], v236 offset:35840
    ds_read_b64_tr_b16 a[236:237], v237 offset:34816
    ds_read_b64_tr_b16 a[238:239], v237 offset:35840
    ds_read_b64_tr_b16 a[240:241], v236 offset:36864
    ds_read_b64_tr_b16 a[242:243], v236 offset:37888
    ds_read_b64_tr_b16 a[244:245], v237 offset:36864
    ds_read_b64_tr_b16 a[246:247], v237 offset:37888
    ds_read_b64_tr_b16 a[248:249], v236 offset:38912
    ds_read_b64_tr_b16 a[250:251], v236 offset:39936
    ds_read_b64_tr_b16 a[252:253], v237 offset:38912
    ds_read_b64_tr_b16 a[254:255], v237 offset:39936
    s_waitcnt lgkmcnt(0)
    s_add_u32 m0, s89, 98304
    s_nop 0
    buffer_load_dwordx4 v192, s[20:23], s95 offen offset:0  lds
    buffer_load_dwordx4 v193, s[20:23], s95 offen offset:1024  lds
    buffer_load_dwordx4 v194, s[20:23], s95 offen offset:2048  lds
    buffer_load_dwordx4 v195, s[20:23], s95 offen offset:3072  lds
    s_add_u32 m0, m0, 4096
    s_add_u32 s95, s95, 32768
    buffer_load_dwordx4 v192, s[20:23], s95 offen offset:0  lds
    buffer_load_dwordx4 v193, s[20:23], s95 offen offset:1024  lds
    buffer_load_dwordx4 v194, s[20:23], s95 offen offset:2048  lds
    buffer_load_dwordx4 v195, s[20:23], s95 offen offset:3072  lds
    s_add_u32 s95, s95, 32768
    s_cmp_ge_u32 s95, s32
    s_cselect_b32 s47, 458752, 0
    s_sub_u32 s95, s95, s47
    s_add_u32 m0, s89, 32768
    s_nop 0
    s_nop 0
    buffer_load_dwordx4 v192, s[20:23], s95 offen offset:0  lds
    buffer_load_dwordx4 v193, s[20:23], s95 offen offset:1024  lds
    buffer_load_dwordx4 v194, s[20:23], s95 offen offset:2048  lds
    buffer_load_dwordx4 v195, s[20:23], s95 offen offset:3072  lds
    s_add_u32 m0, m0, 4096
    s_add_u32 s95, s95, 32768
    buffer_load_dwordx4 v192, s[20:23], s95 offen offset:0  lds
    buffer_load_dwordx4 v193, s[20:23], s95 offen offset:1024  lds
    buffer_load_dwordx4 v194, s[20:23], s95 offen offset:2048  lds
    buffer_load_dwordx4 v195, s[20:23], s95 offen offset:3072  lds
    s_add_u32 s95, s95, 32768
    s_cmp_ge_u32 s95, s32
    s_cselect_b32 s47, 458752, 0
    s_sub_u32 s95, s95, s47
    s_lshr_b32 s40, s87, 1
    s_lshl_b32 s40, s40, 11
    s_add_u32 s38, s40, 0xb80000
    s_add_u32 s39, s40, 0xb88000
    v_lshlrev_b32 v245, 5, v1
    s_lshr_b32 s41, s3, 1
    s_lshl_b32 s40, s41, 8
    v_xor_b32 v249, s40, v3
    s_mul_i32 s43, s87, 114688
    s_mul_i32 s40, s3, 28672
    s_add_u32 s43, s43, s40
    s_add_u32 s43, s43, 0x440000
    s_add_u32 s35, s43, 28672
    s_lshl_b32 s40, s37, 12
    s_add_u32 s43, s43, s40
    v_and_b32 v246, 31, v1
    s_lshl_b32 s40, s69, 5
    v_add_u32 v246, s40, v246
    v_mul_u32_u24 v247, 4352, v246
    v_lshl_add_u32 v247, v6, 4, v247
    s_lshl_b32 s44, s87, 6
    s_lshl_b32 s40, s41, 5
    s_add_u32 s44, s44, s40
    s_add_u32 s44, s44, 0x220000
    v_lshlrev_b32 v246, 1, v246
    v_lshl_add_u32 v248, v6, 12, v246
    s_lshl_b32 s45, s87, 15
    s_lshl_b32 s40, s41, 14
    s_add_u32 s45, s45, s40
    s_add_u32 s46, s45, 8192
    s_mul_i32 s40, s3, 6144
    v_add_u32 v12, s40, v3
    s_xor_b32 s40, s3, 1
    s_mul_i32 s40, s40, 6144
    s_add_u32 s40, s40, 0
    v_add_u32 v13, s40, v3
    s_xor_b32 s40, s3, 2
    s_mul_i32 s40, s40, 6144
    s_add_u32 s40, s40, 2048
    v_add_u32 v14, s40, v3
    s_xor_b32 s40, s3, 3
    s_mul_i32 s40, s40, 6144
    s_add_u32 s40, s40, 4096
    v_add_u32_e64 v15, s40, v3
    buffer_load_dwordx4 v[176:179], v247, s[8:11], s44 offen sc1
    global_load_ushort v251, v246, s[58:59]
    s_mov_b64 exec, 0x3fff
    buffer_load_dword v254, v245, s[8:11], s38 offen sc1
    s_mov_b64 exec, -1
    s_waitcnt vmcnt(0)
    s_mov_b64 exec, 0x3fff
    s_mov_b32 s72, 0
    s_branch L_pCA2_c
L_pCA2:
    buffer_load_dword v254, v245, s[8:11], s38 offen sc1
    s_waitcnt vmcnt(0)
L_pCA2_c:
    s_add_u32 s72, s72, 1
    v_cmp_ne_u32 vcc, s28, v254
    s_cmp_gt_u32 s72, 262144
    s_cbranch_scc1 L_pCA2_x
    s_and_b64 exec, exec, vcc
    s_cbranch_execnz L_pCA2
L_pCA2_x:
    s_mov_b64 exec, -1
    s_barrier
    s_mov_b32 s81, 1
    buffer_load_dwordx4 v[64:67], v249, s[8:11], s43 offen offset:0 sc1
    buffer_load_dwordx4 v[68:71], v249, s[8:11], s43 offen offset:1024 sc1
    buffer_load_dwordx4 v[72:75], v249, s[8:11], s43 offen offset:2048 sc1
    buffer_load_dwordx4 v[76:79], v249, s[8:11], s43 offen offset:3072 sc1
    s_add_u32 s43, s43, 4096
    s_cmp_ge_u32 s43, s35
    s_cselect_b32 s47, 28672, 0
    s_sub_u32 s43, s43, s47
    buffer_load_dwordx4 v[80:83], v249, s[8:11], s43 offen offset:0 sc1
    buffer_load_dwordx4 v[84:87], v249, s[8:11], s43 offen offset:1024 sc1
    buffer_load_dwordx4 v[88:91], v249, s[8:11], s43 offen offset:2048 sc1
    buffer_load_dwordx4 v[92:95], v249, s[8:11], s43 offen offset:3072 sc1
    s_add_u32 s43, s43, 4096
    s_cmp_ge_u32 s43, s35
    s_cselect_b32 s47, 28672, 0
    s_sub_u32 s43, s43, s47
L_join:
    s_waitcnt vmcnt(39)
    v_lshlrev_b32 v251, 16, v251
    s_waitcnt lgkmcnt(15)
    s_add_u32 m0, s89, 65536
    s_nop 0
    s_nop 0
    buffer_load_dwordx4 v192, s[20:23], s95 offen offset:0  lds
    buffer_load_dwordx4 v193, s[20:23], s95 offen offset:1024  lds
    buffer_load_dwordx4 v194, s[20:23], s95 offen offset:2048  lds
    buffer_load_dwordx4 v195, s[20:23], s95 offen offset:3072  lds
    s_add_u32 m0, m0, 4096
    s_add_u32 s95, s95, 32768
    buffer_load_dwordx4 v192, s[20:23], s95 offen offset:0  lds
    buffer_load_dwordx4 v193, s[20:23], s95 offen offset:1024  lds
    buffer_load_dwordx4 v194, s[20:23], s95 offen offset:2048  lds
    buffer_load_dwordx4 v195, s[20:23], s95 offen offset:3072  lds
    s_add_u32 s95, s95, 32768
    s_cmp_ge_u32 s95, s32
    s_cselect_b32 s47, 458752, 0
    s_sub_u32 s95, s95, s47
    s_waitcnt vmcnt(31)
    s_nop 0
    ds_read_b64_tr_b16 a[0:1], v238 offset:0
    ds_read_b64_tr_b16 a[2:3], v238 offset:1024
    ds_read_b64_tr_b16 a[4:5], v239 offset:0
    ds_read_b64_tr_b16 a[6:7], v239 offset:1024
    ds_read_b64_tr_b16 a[8:9], v238 offset:2048
    ds_read_b64_tr_b16 a[10:11], v238 offset:3072
    ds_read_b64_tr_b16 a[12:13], v239 offset:2048
    ds_read_b64_tr_b16 a[14:15], v239 offset:3072
    ds_read_b64_tr_b16 a[16:17], v238 offset:4096
    ds_read_b64_tr_b16 a[18:19], v238 offset:5120
    ds_read_b64_tr_b16 a[20:21], v239 offset:4096
    ds_read_b64_tr_b16 a[22:23], v239 offset:5120
    ds_read_b64_tr_b16 a[24:25], v238 offset:6144
    ds_read_b64_tr_b16 a[26:27], v238 offset:7168
    ds_read_b64_tr_b16 a[28:29], v239 offset:6144
    ds_read_b64_tr_b16 a[30:31], v239 offset:7168
    s_waitcnt vmcnt(23)
    s_nop 0
    ds_read_b64_tr_b16 a[32:33], v236 offset:0
    ds_read_b64_tr_b16 a[34:35], v236 offset:1024
    ds_read_b64_tr_b16 a[36:37], v237 offset:0
    ds_read_b64_tr_b16 a[38:39], v237 offset:1024
    ds_read_b64_tr_b16 a[40:41], v236 offset:2048
    ds_read_b64_tr_b16 a[42:43], v236 offset:3072
    ds_read_b64_tr_b16 a[44:45], v237 offset:2048
    ds_read_b64_tr_b16 a[46:47], v237 offset:3072
    ds_read_b64_tr_b16 a[48:49], v236 offset:4096
    ds_read_b64_tr_b16 a[50:51], v236 offset:5120
    ds_read_b64_tr_b16 a[52:53], v237 offset:4096
    ds_read_b64_tr_b16 a[54:55], v237 offset:5120
    ds_read_b64_tr_b16 a[56:57], v236 offset:6144
    ds_read_b64_tr_b16 a[58:59], v236 offset:7168
    ds_read_b64_tr_b16 a[60:61], v237 offset:6144
    ds_read_b64_tr_b16 a[62:63], v237 offset:7168
    v_permlane32_swap_b32 v176, v178
    v_permlane32_swap_b32 v177, v179
    v_lshlrev_b32 v32, 16, v176
    v_and_b32 v33, 0xffff0000, v176
    v_lshlrev_b32 v34, 16, v177
    v_and_b32 v35, 0xffff0000, v177
    v_lshlrev_b32 v36, 16, v178
    v_and_b32 v37, 0xffff0000, v178
    v_lshlrev_b32 v38, 16, v179
    v_and_b32 v39, 0xffff0000, v179
    v_add_f32 v32, v32, v251
    v_add_f32 v33, v33, v251
    v_add_f32 v34, v34, v251
    v_add_f32 v35, v35, v251
    v_add_f32 v36, v36, v251
    v_add_f32 v37, v37, v251
    v_add_f32 v38, v38, v251
    v_add_f32 v39, v39, v251
    v_mov_b32 v40, 0
    v_mov_b32 v41, 0
    v_mov_b32 v42, 0
    v_mov_b32 v43, 0
    v_mov_b32 v44, 0
    v_mov_b32 v45, 0
    v_mov_b32 v46, 0
    v_mov_b32 v47, 0
    s_waitcnt vmcnt(15)
    v_mfma_f32_32x32x16_bf16 v[48:63], v[64:67], a[132:135], 0
    buffer_load_dwordx4 v[212:215], v249, s[8:11], s43 offen offset:0 sc1
    s_waitcnt vmcnt(17)
    s_barrier
    s_cmp_lg_u32 s81, 0
    s_cbranch_scc1 L_nf4
    s_mov_b64 exec, 1
    buffer_store_dword v252, v253, s[8:11], s94 offen sc1
    s_mov_b64 exec, -1
L_nf4:
    v_mfma_f32_32x32x16_bf16 v[32:47], v[64:67], a[128:131], v[32:47]
    buffer_load_dwordx4 v[216:219], v249, s[8:11], s43 offen offset:1024 sc1
    s_waitcnt vmcnt(16)
    v_mfma_f32_32x32x16_bf16 v[48:63], v[68:71], a[140:143], v[48:63]
    buffer_load_dwordx4 v[220:223], v249, s[8:11], s43 offen offset:2048 sc1
    v_mfma_f32_32x32x16_bf16 v[32:47], v[68:71], a[136:139], v[32:47]
    s_waitcnt vmcnt(16)
    v_mfma_f32_32x32x16_bf16 v[48:63], v[72:75], a[148:151], v[48:63]
    buffer_load_dwordx4 v[224:227], v249, s[8:11], s43 offen offset:3072 sc1
    v_mfma_f32_32x32x16_bf16 v[32:47], v[72:75], a[144:147], v[32:47]
    s_add_u32 s43, s43, 4096
    s_cmp_ge_u32 s43, s35
    s_cselect_b32 s47, 28672, 0
    s_sub_u32 s43, s43, s47
    s_waitcnt vmcnt(4)
    ds_read_b64_tr_b16 a[64:65], v236 offset:32768
    ds_read_b64_tr_b16 a[66:67], v236 offset:33792
    ds_read_b64_tr_b16 a[68:69], v237 offset:32768
    s_waitcnt vmcnt(16)
    v_mfma_f32_32x32x16_bf16 v[48:63], v[76:79], a[156:159], v[48:63]
    ds_read_b64_tr_b16 a[70:71], v237 offset:33792
    ds_read_b64_tr_b16 a[72:73], v236 offset:34816
    v_mfma_f32_32x32x16_bf16 v[32:47], v[76:79], a[152:155], v[32:47]
    buffer_load_dwordx4 v[228:231], v249, s[8:11], s43 offen offset:0 sc1
    ds_read_b64_tr_b16 a[74:75], v236 offset:35840
    ds_read_b64_tr_b16 a[76:77], v237 offset:34816
    s_waitcnt vmcnt(16)
    v_mfma_f32_32x32x16_bf16 v[48:63], v[80:83], a[164:167], v[48:63]
    buffer_load_dwordx4 v[232:235], v249, s[8:11], s43 offen offset:1024 sc1
    ds_read_b64_tr_b16 a[78:79], v237 offset:35840
    ds_read_b64_tr_b16 a[80:81], v236 offset:36864
    v_mfma_f32_32x32x16_bf16 v[32:47], v[80:83], a[160:163], v[32:47]
    ds_read_b64_tr_b16 a[82:83], v236 offset:37888
    ds_read_b64_tr_b16 a[84:85], v237 offset:36864
    s_waitcnt vmcnt(16)
    v_mfma_f32_32x32x16_bf16 v[48:63], v[84:87], a[172:175], v[48:63]
    buffer_load_dwordx4 v[196:199], v249, s[8:11], s43 offen offset:2048 sc1
    ds_read_b64_tr_b16 a[86:87], v237 offset:37888
    ds_read_b64_tr_b16 a[88:89], v236 offset:38912
    v_mfma_f32_32x32x16_bf16 v[32:47], v[84:87], a[168:171], v[32:47]
    buffer_load_dwordx4 v[200:203], v249, s[8:11], s43 offen offset:3072 sc1
    ds_read_b64_tr_b16 a[90:91], v236 offset:39936
    ds_read_b64_tr_b16 a[92:93], v237 offset:38912
    s_waitcnt vmcnt(17)
    v_mfma_f32_32x32x16_bf16 v[48:63], v[88:91], a[180:183], v[48:63]
    s_add_u32 s43, s43, 4096
    s_cmp_ge_u32 s43, s35
    s_cselect_b32 s47, 28672, 0
    s_sub_u32 s43, s43, s47
    ds_read_b64_tr_b16 a[94:95], v237 offset:39936
    v_mfma_f32_32x32x16_bf16 v[32:47], v[88:91], a[176:179], v[32:47]
    s_waitcnt vmcnt(16)
    v_mfma_f32_32x32x16_bf16 v[48:63], v[92:95], a[188:191], v[48:63]
    buffer_load_dwordx4 v[204:207], v249, s[8:11], s43 offen offset:0 sc1
    v_mfma_f32_32x32x16_bf16 v[32:47], v[92:95], a[184:187], v[32:47]
    buffer_load_dwordx4 v[208:211], v249, s[8:11], s43 offen offset:1024 sc1
    s_waitcnt vmcnt(9)
    v_mfma_f32_32x32x16_bf16 v[48:63], v[212:215], a[196:199], v[48:63]
    v_mfma_f32_32x32x16_bf16 v[32:47], v[212:215], a[192:195], v[32:47]
    buffer_load_dwordx4 v[64:67], v249, s[8:11], s43 offen offset:2048 sc1
    s_waitcnt vmcnt(9)
    v_mfma_f32_32x32x16_bf16 v[48:63], v[216:219], a[204:207], v[48:63]
    buffer_load_dwordx4 v[68:71], v249, s[8:11], s43 offen offset:3072 sc1
    v_mfma_f32_32x32x16_bf16 v[32:47], v[216:219], a[200:203], v[32:47]
    s_waitcnt vmcnt(9)
    v_mfma_f32_32x32x16_bf16 v[48:63], v[220:223], a[212:215], v[48:63]
    s_add_u32 s43, s43, 4096
    s_cmp_ge_u32 s43, s35
    s_cselect_b32 s47, 28672, 0
    s_sub_u32 s43, s43, s47
    v_mfma_f32_32x32x16_bf16 v[32:47], v[220:223], a[208:211], v[32:47]
    buffer_load_dwordx4 v[72:75], v249, s[8:11], s43 offen offset:0 sc1
    s_waitcnt vmcnt(9)
    v_mfma_f32_32x32x16_bf16 v[48:63], v[224:227], a[220:223], v[48:63]
    buffer_load_dwordx4 v[76:79], v249, s[8:11], s43 offen offset:1024 sc1
    v_mfma_f32_32x32x16_bf16 v[32:47], v[224:227], a[216:219], v[32:47]
    s_waitcnt vmcnt(9)
    v_mfma_f32_32x32x16_bf16 v[48:63], v[228:231], a[228:231], v[48:63]
    buffer_load_dwordx4 v[80:83], v249, s[8:11], s43 offen offset:2048 sc1
    v_mfma_f32_32x32x16_bf16 v[32:47], v[228:231], a[224:227], v[32:47]
    buffer_load_dwordx4 v[84:87], v249, s[8:11], s43 offen offset:3072 sc1
    s_waitcnt vmcnt(10)
    v_mfma_f32_32x32x16_bf16 v[48:63], v[232:235], a[236:239], v[48:63]
    v_mfma_f32_32x32x16_bf16 v[32:47], v[232:235], a[232:235], v[32:47]
    s_add_u32 s43, s43, 4096
    s_cmp_ge_u32 s43, s35
    s_cselect_b32 s47, 28672, 0
    s_sub_u32 s43, s43, s47
    s_waitcnt vmcnt(9)
    v_mfma_f32_32x32x16_bf16 v[48:63], v[196:199], a[244:247], v[48:63]
    buffer_load_dwordx4 v[88:91], v249, s[8:11], s43 offen offset:0 sc1
    v_mfma_f32_32x32x16_bf16 v[32:47], v[196:199], a[240:243], v[32:47]
    s_waitcnt vmcnt(9)
    v_mfma_f32_32x32x16_bf16 v[48:63], v[200:203], a[252:255], v[48:63]
    buffer_load_dwordx4 v[92:95], v249, s[8:11], s43 offen offset:1024 sc1
    v_mfma_f32_32x32x16_bf16 v[32:47], v[200:203], a[248:251], v[32:47]
    buffer_load_dwordx4 v[212:215], v249, s[8:11], s43 offen offset:2048 sc1
    s_waitcnt vmcnt(10)
    s_waitcnt lgkmcnt(15)
    v_mfma_f32_32x32x16_bf16 v[48:63], v[204:207], a[4:7], v[48:63]
    buffer_load_dwordx4 v[216:219], v249, s[8:11], s43 offen offset:3072 sc1
    v_mfma_f32_32x32x16_bf16 v[32:47], v[204:207], a[0:3], v[32:47]
    s_waitcnt vmcnt(10)
    v_mfma_f32_32x32x16_bf16 v[48:63], v[208:211], a[12:15], v[48:63]
    s_add_u32 s43, s43, 4096
    s_cmp_ge_u32 s43, s35
    s_cselect_b32 s47, 28672, 0
    s_sub_u32 s43, s43, s47
    v_mfma_f32_32x32x16_bf16 v[32:47], v[208:211], a[8:11], v[32:47]
    s_waitcnt vmcnt(9)
    v_mfma_f32_32x32x16_bf16 v[48:63], v[64:67], a[20:23], v[48:63]
    v_mfma_f32_32x32x16_bf16 v[32:47], v[64:67], a[16:19], v[32:47]
    s_waitcnt vmcnt(8)
    v_mfma_f32_32x32x16_bf16 v[48:63], v[68:71], a[28:31], v[48:63]
    v_mfma_f32_32x32x16_bf16 v[32:47], v[68:71], a[24:27], v[32:47]
    s_waitcnt vmcnt(7)
    v_mfma_f32_32x32x16_bf16 v[48:63], v[72:75], a[36:39], v[48:63]
    v_mfma_f32_32x32x16_bf16 v[32:47], v[72:75], a[32:35], v[32:47]
    s_waitcnt vmcnt(6)
    v_mfma_f32_32x32x16_bf16 v[48:63], v[76:79], a[44:47], v[48:63]
    v_mfma_f32_32x32x16_bf16 v[32:47], v[76:79], a[40:43], v[32:47]
    s_waitcnt vmcnt(5)
    v_mfma_f32_32x32x16_bf16 v[48:63], v[80:83], a[52:55], v[48:63]
    v_mfma_f32_32x32x16_bf16 v[32:47], v[80:83], a[48:51], v[32:47]
    s_waitcnt vmcnt(4)
    v_mfma_f32_32x32x16_bf16 v[48:63], v[84:87], a[60:63], v[48:63]
    v_mfma_f32_32x32x16_bf16 v[32:47], v[84:87], a[56:59], v[32:47]
    s_waitcnt vmcnt(3)
    s_waitcnt lgkmcnt(0)
    v_mfma_f32_32x32x16_bf16 v[48:63], v[88:91], a[68:71], v[48:63]
    v_mfma_f32_32x32x16_bf16 v[32:47], v[88:91], a[64:67], v[32:47]
    s_waitcnt vmcnt(2)
    v_mfma_f32_32x32x16_bf16 v[48:63], v[92:95], a[76:79], v[48:63]
    buffer_load_dwordx4 v[180:183], v247, s[8:11], s44 offen offset:2048 sc1
    s_mov_b64 exec, 0x3fff
    buffer_load_dword v254, v245, s[8:11], s39 offen sc1
    s_mov_b64 exec, -1
    v_mfma_f32_32x32x16_bf16 v[32:47], v[92:95], a[72:75], v[32:47]
    s_waitcnt vmcnt(3)
    v_mfma_f32_32x32x16_bf16 v[48:63], v[212:215], a[84:87], v[48:63]
    v_mfma_f32_32x32x16_bf16 v[32:47], v[212:215], a[80:83], v[32:47]
    s_waitcnt vmcnt(2)
    v_mfma_f32_32x32x16_bf16 v[48:63], v[216:219], a[92:95], v[48:63]
    v_mfma_f32_32x32x16_bf16 v[32:47], v[216:219], a[88:91], v[32:47]
    s_nop 10
    ds_write_b128 v13, v[48:51] offset:0
    ds_write_b128 v13, v[52:55] offset:1024
    ds_write_b128 v15, v[56:59] offset:0
    ds_write_b128 v15, v[60:63] offset:1024
    ds_write_b128 v14, v[40:43] offset:0
    ds_write_b128 v14, v[44:47] offset:1024
    s_waitcnt lgkmcnt(0)
    s_barrier
    s_nop 0
    ds_read_b128 v[96:99], v12 offset:0
    ds_read_b128 v[104:107], v12 offset:2048
    ds_read_b128 v[112:115], v12 offset:4096
    ds_read_b128 v[100:103], v12 offset:1024
    ds_read_b128 v[108:111], v12 offset:3072
    ds_read_b128 v[116:119], v12 offset:5120
    s_add_u32 s43, s43, 3670016
    s_add_u32 s35, s35, 3670016
    s_waitcnt vmcnt(0)
    s_mov_b64 exec, 0x3fff
    s_mov_b32 s72, 0
    s_branch L_pCB_c
L_pCB:
    buffer_load_dword v254, v245, s[8:11], s39 offen sc1
    s_waitcnt vmcnt(0)
L_pCB_c:
    s_add_u32 s72, s72, 1
    v_cmp_ne_u32 vcc, s28, v254
    s_cmp_gt_u32 s72, 262144
    s_cbranch_scc1 L_pCB_x
    s_and_b64 exec, exec, vcc
    s_cbranch_execnz L_pCB
L_pCB_x:
    s_mov_b64 exec, -1
    buffer_load_dwordx4 v[64:67], v249, s[8:11], s43 offen offset:0 sc1
    buffer_load_dwordx4 v[68:71], v249, s[8:11], s43 offen offset:1024 sc1
    buffer_load_dwordx4 v[72:75], v249, s[8:11], s43 offen offset:2048 sc1
    buffer_load_dwordx4 v[76:79], v249, s[8:11], s43 offen offset:3072 sc1
    s_add_u32 s43, s43, 4096
    s_cmp_ge_u32 s43, s35
    s_cselect_b32 s47, 28672, 0
    s_sub_u32 s43, s43, s47
    buffer_load_dwordx4 v[80:83], v249, s[8:11], s43 offen offset:0 sc1
    buffer_load_dwordx4 v[84:87], v249, s[8:11], s43 offen offset:1024 sc1
    buffer_load_dwordx4 v[88:91], v249, s[8:11], s43 offen offset:2048 sc1
    buffer_load_dwordx4 v[92:95], v249, s[8:11], s43 offen offset:3072 sc1
    s_add_u32 s43, s43, 4096
    s_cmp_ge_u32 s43, s35
    s_cselect_b32 s47, 28672, 0
    s_sub_u32 s43, s43, s47
    s_waitcnt lgkmcnt(3)
    s_nop 0
    v_pk_add_f32 v[96:97], v[96:97], v[104:105]
    v_pk_add_f32 v[120:121], v[32:33], v[112:113]
    v_pk_add_f32 v[98:99], v[98:99], v[106:107]
    v_pk_add_f32 v[122:123], v[34:35], v[114:115]
    v_pk_add_f32 v[120:121], v[120:121], v[96:97]
    v_pk_add_f32 v[122:123], v[122:123], v[98:99]
    v_cvt_pk_bf16_f32 v120, v120, v121
    v_cvt_pk_bf16_f32 v122, v122, v123
    buffer_store_short v120, v248, s[24:27], s45 offen offset:0
    buffer_store_short_d16_hi v120, v248, s[24:27], s45 offen offset:1024
    buffer_store_short v122, v248, s[24:27], s45 offen offset:2048
    buffer_store_short_d16_hi v122, v248, s[24:27], s45 offen offset:3072
    s_waitcnt lgkmcnt(0)
    s_nop 0
    v_pk_add_f32 v[100:101], v[100:101], v[108:109]
    v_pk_add_f32 v[124:125], v[36:37], v[116:117]
    v_pk_add_f32 v[102:103], v[102:103], v[110:111]
    v_pk_add_f32 v[126:127], v[38:39], v[118:119]
    v_pk_add_f32 v[124:125], v[124:125], v[100:101]
    v_pk_add_f32 v[126:127], v[126:127], v[102:103]
    v_cvt_pk_bf16_f32 v124, v124, v125
    v_cvt_pk_bf16_f32 v126, v126, v127
    buffer_store_short v124, v248, s[24:27], s46 offen offset:0
    buffer_store_short_d16_hi v124, v248, s[24:27], s46 offen offset:1024
    buffer_store_short v126, v248, s[24:27], s46 offen offset:2048
    buffer_store_short_d16_hi v126, v248, s[24:27], s46 offen offset:3072
    s_add_u32 s45, s45, 1048576
    s_add_u32 s46, s46, 1048576
    v_permlane32_swap_b32 v180, v182
    v_permlane32_swap_b32 v181, v183
    v_lshlrev_b32 v32, 16, v180
    v_and_b32 v33, 0xffff0000, v180
    v_lshlrev_b32 v34, 16, v181
    v_and_b32 v35, 0xffff0000, v181
    v_lshlrev_b32 v36, 16, v182
    v_and_b32 v37, 0xffff0000, v182
    v_lshlrev_b32 v38, 16, v183
    v_and_b32 v39, 0xffff0000, v183
    v_add_f32 v32, v32, v251
    v_add_f32 v33, v33, v251
    v_add_f32 v34, v34, v251
    v_add_f32 v35, v35, v251
    v_add_f32 v36, v36, v251
    v_add_f32 v37, v37, v251
    v_add_f32 v38, v38, v251
    v_add_f32 v39, v39, v251
    v_mov_b32 v40, 0
    v_mov_b32 v41, 0
    v_mov_b32 v42, 0
    v_mov_b32 v43, 0
    v_mov_b32 v44, 0
    v_mov_b32 v45, 0
    v_mov_b32 v46, 0
    v_mov_b32 v47, 0
    s_waitcnt vmcnt(15)
    v_mfma_f32_32x32x16_bf16 v[48:63], v[64:67], a[132:135], 0
    buffer_load_dwordx4 v[212:215], v249, s[8:11], s43 offen offset:0 sc1
    v_mfma_f32_32x32x16_bf16 v[32:47], v[64:67], a[128:131], v[32:47]
    buffer_load_dwordx4 v[216:219], v249, s[8:11], s43 offen offset:1024 sc1
    s_waitcnt vmcnt(16)
    v_mfma_f32_32x32x16_bf16 v[48:63], v[68:71], a[140:143], v[48:63]
    buffer_load_dwordx4 v[220:223], v249, s[8:11], s43 offen offset:2048 sc1
    v_mfma_f32_32x32x16_bf16 v[32:47], v[68:71], a[136:139], v[32:47]
    s_waitcnt vmcnt(16)
    v_mfma_f32_32x32x16_bf16 v[48:63], v[72:75], a[148:151], v[48:63]
    buffer_load_dwordx4 v[224:227], v249, s[8:11], s43 offen offset:3072 sc1
    v_mfma_f32_32x32x16_bf16 v[32:47], v[72:75], a[144:147], v[32:47]
    s_add_u32 s43, s43, 4096
    s_cmp_ge_u32 s43, s35
    s_cselect_b32 s47, 28672, 0
    s_sub_u32 s43, s43, s47
    s_waitcnt vmcnt(16)
    v_mfma_f32_32x32x16_bf16 v[48:63], v[76:79], a[156:159], v[48:63]
    v_mfma_f32_32x32x16_bf16 v[32:47], v[76:79], a[152:155], v[32:47]
    buffer_load_dwordx4 v[228:231], v249, s[8:11], s43 offen offset:0 sc1
    s_waitcnt vmcnt(16)
    v_mfma_f32_32x32x16_bf16 v[48:63], v[80:83], a[164:167], v[48:63]
    buffer_load_dwordx4 v[232:235], v249, s[8:11], s43 offen offset:1024 sc1
    v_mfma_f32_32x32x16_bf16 v[32:47], v[80:83], a[160:163], v[32:47]
    s_waitcnt vmcnt(16)
    v_mfma_f32_32x32x16_bf16 v[48:63], v[84:87], a[172:175], v[48:63]
    buffer_load_dwordx4 v[196:199], v249, s[8:11], s43 offen offset:2048 sc1
    v_mfma_f32_32x32x16_bf16 v[32:47], v[84:87], a[168:171], v[32:47]
    buffer_load_dwordx4 v[200:203], v249, s[8:11], s43 offen offset:3072 sc1
    s_waitcnt vmcnt(17)
    v_mfma_f32_32x32x16_bf16 v[48:63], v[88:91], a[180:183], v[48:63]
    s_add_u32 s43, s43, 4096
    s_cmp_ge_u32 s43, s35
    s_cselect_b32 s47, 28672, 0
    s_sub_u32 s43, s43, s47
    v_mfma_f32_32x32x16_bf16 v[32:47], v[88:91], a[176:179], v[32:47]
    s_waitcnt vmcnt(16)
    v_mfma_f32_32x32x16_bf16 v[48:63], v[92:95], a[188:191], v[48:63]
    buffer_load_dwordx4 v[204:207], v249, s[8:11], s43 offen offset:0 sc1
    v_mfma_f32_32x32x16_bf16 v[32:47], v[92:95], a[184:187], v[32:47]
    buffer_load_dwordx4 v[208:211], v249, s[8:11], s43 offen offset:1024 sc1
    s_waitcnt vmcnt(9)
    v_mfma_f32_32x32x16_bf16 v[48:63], v[212:215], a[196:199], v[48:63]
    v_mfma_f32_32x32x16_bf16 v[32:47], v[212:215], a[192:195], v[32:47]
    buffer_load_dwordx4 v[64:67], v249, s[8:11], s43 offen offset:2048 sc1
    s_waitcnt vmcnt(9)
    v_mfma_f32_32x32x16_bf16 v[48:63], v[216:219], a[204:207], v[48:63]
    buffer_load_dwordx4 v[68:71], v249, s[8:11], s43 offen offset:3072 sc1
    v_mfma_f32_32x32x16_bf16 v[32:47], v[216:219], a[200:203], v[32:47]
    s_waitcnt vmcnt(9)
    v_mfma_f32_32x32x16_bf16 v[48:63], v[220:223], a[212:215], v[48:63]
    s_add_u32 s43, s43, 4096
    s_cmp_ge_u32 s43, s35
    s_cselect_b32 s47, 28672, 0
    s_sub_u32 s43, s43, s47
    v_mfma_f32_32x32x16_bf16 v[32:47], v[220:223], a[208:211], v[32:47]
    buffer_load_dwordx4 v[72:75], v249, s[8:11], s43 offen offset:0 sc1
    s_waitcnt vmcnt(9)
    v_mfma_f32_32x32x16_bf16 v[48:63], v[224:227], a[220:223], v[48:63]
    buffer_load_dwordx4 v[76:79], v249, s[8:11], s43 offen offset:1024 sc1
    v_mfma_f32_32x32x16_bf16 v[32:47], v[224:227], a[216:219], v[32:47]
    s_waitcnt vmcnt(9)
    v_mfma_f32_32x32x16_bf16 v[48:63], v[228:231], a[228:231], v[48:63]
    buffer_load_dwordx4 v[80:83], v249, s[8:11], s43 offen offset:2048 sc1
    v_mfma_f32_32x32x16_bf16 v[32:47], v[228:231], a[224:227], v[32:47]
    buffer_load_dwordx4 v[84:87], v249, s[8:11], s43 offen offset:3072 sc1
    s_waitcnt vmcnt(10)
    v_mfma_f32_32x32x16_bf16 v[48:63], v[232:235], a[236:239], v[48:63]
    v_mfma_f32_32x32x16_bf16 v[32:47], v[232:235], a[232:235], v[32:47]
    s_add_u32 s43, s43, 4096
    s_cmp_ge_u32 s43, s35
    s_cselect_b32 s47, 28672, 0
    s_sub_u32 s43, s43, s47
    s_waitcnt vmcnt(9)
    v_mfma_f32_32x32x16_bf16 v[48:63], v[196:199], a[244:247], v[48:63]
    buffer_load_dwordx4 v[88:91], v249, s[8:11], s43 offen offset:0 sc1
    v_mfma_f32_32x32x16_bf16 v[32:47], v[196:199], a[240:243], v[32:47]
    s_waitcnt vmcnt(9)
    v_mfma_f32_32x32x16_bf16 v[48:63], v[200:203], a[252:255], v[48:63]
    buffer_load_dwordx4 v[92:95], v249, s[8:11], s43 offen offset:1024 sc1
    v_mfma_f32_32x32x16_bf16 v[32:47], v[200:203], a[248:251], v[32:47]
    buffer_load_dwordx4 v[212:215], v249, s[8:11], s43 offen offset:2048 sc1
    s_waitcnt vmcnt(10)
    v_mfma_f32_32x32x16_bf16 v[48:63], v[204:207], a[4:7], v[48:63]
    buffer_load_dwordx4 v[216:219], v249, s[8:11], s43 offen offset:3072 sc1
    v_mfma_f32_32x32x16_bf16 v[32:47], v[204:207], a[0:3], v[32:47]
    s_waitcnt vmcnt(10)
    v_mfma_f32_32x32x16_bf16 v[48:63], v[208:211], a[12:15], v[48:63]
    s_add_u32 s43, s43, 4096
    s_cmp_ge_u32 s43, s35
    s_cselect_b32 s47, 28672, 0
    s_sub_u32 s43, s43, s47
    v_mfma_f32_32x32x16_bf16 v[32:47], v[208:211], a[8:11], v[32:47]
    s_waitcnt vmcnt(9)
    v_mfma_f32_32x32x16_bf16 v[48:63], v[64:67], a[20:23], v[48:63]
    v_mfma_f32_32x32x16_bf16 v[32:47], v[64:67], a[16:19], v[32:47]
    s_waitcnt vmcnt(8)
    v_mfma_f32_32x32x16_bf16 v[48:63], v[68:71], a[28:31], v[48:63]
    v_mfma_f32_32x32x16_bf16 v[32:47], v[68:71], a[24:27], v[32:47]
    s_waitcnt vmcnt(7)
    v_mfma_f32_32x32x16_bf16 v[48:63], v[72:75], a[36:39], v[48:63]
    v_mfma_f32_32x32x16_bf16 v[32:47], v[72:75], a[32:35], v[32:47]
    s_waitcnt vmcnt(6)
    v_mfma_f32_32x32x16_bf16 v[48:63], v[76:79], a[44:47], v[48:63]
    v_mfma_f32_32x32x16_bf16 v[32:47], v[76:79], a[40:43], v[32:47]
    s_waitcnt vmcnt(5)
    v_mfma_f32_32x32x16_bf16 v[48:63], v[80:83], a[52:55], v[48:63]
    v_mfma_f32_32x32x16_bf16 v[32:47], v[80:83], a[48:51], v[32:47]
    s_waitcnt vmcnt(4)
    v_mfma_f32_32x32x16_bf16 v[48:63], v[84:87], a[60:63], v[48:63]
    v_mfma_f32_32x32x16_bf16 v[32:47], v[84:87], a[56:59], v[32:47]
    s_waitcnt vmcnt(3)
    v_mfma_f32_32x32x16_bf16 v[48:63], v[88:91], a[68:71], v[48:63]
    v_mfma_f32_32x32x16_bf16 v[32:47], v[88:91], a[64:67], v[32:47]
    s_waitcnt vmcnt(2)
    v_mfma_f32_32x32x16_bf16 v[48:63], v[92:95], a[76:79], v[48:63]
    v_mfma_f32_32x32x16_bf16 v[32:47], v[92:95], a[72:75], v[32:47]
    s_waitcnt vmcnt(1)
    v_mfma_f32_32x32x16_bf16 v[48:63], v[212:215], a[84:87], v[48:63]
    v_mfma_f32_32x32x16_bf16 v[32:47], v[212:215], a[80:83], v[32:47]
    s_waitcnt vmcnt(0)
    v_mfma_f32_32x32x16_bf16 v[48:63], v[216:219], a[92:95], v[48:63]
    v_mfma_f32_32x32x16_bf16 v[32:47], v[216:219], a[88:91], v[32:47]
    v_add_u32 v12, 0x20000, v12
    v_add_u32 v13, 0x20000, v13
    v_add_u32 v14, 0x20000, v14
    v_add_u32 v15, 0x20000, v15
    s_nop 6
    ds_write_b128 v13, v[48:51] offset:0
    ds_write_b128 v13, v[52:55] offset:1024
    ds_write_b128 v15, v[56:59] offset:0
    ds_write_b128 v15, v[60:63] offset:1024
    ds_write_b128 v14, v[40:43] offset:0
    ds_write_b128 v14, v[44:47] offset:1024
    s_waitcnt lgkmcnt(0)
    s_barrier
    ds_read_b128 v[96:99], v12 offset:0
    ds_read_b128 v[104:107], v12 offset:2048
    ds_read_b128 v[112:115], v12 offset:4096
    ds_read_b128 v[100:103], v12 offset:1024
    ds_read_b128 v[108:111], v12 offset:3072
    ds_read_b128 v[116:119], v12 offset:5120
    s_waitcnt lgkmcnt(3)
    v_pk_add_f32 v[96:97], v[96:97], v[104:105]
    v_pk_add_f32 v[120:121], v[32:33], v[112:113]
    v_pk_add_f32 v[98:99], v[98:99], v[106:107]
    v_pk_add_f32 v[122:123], v[34:35], v[114:115]
    v_pk_add_f32 v[120:121], v[120:121], v[96:97]
    v_pk_add_f32 v[122:123], v[122:123], v[98:99]
    v_cvt_pk_bf16_f32 v120, v120, v121
    v_cvt_pk_bf16_f32 v122, v122, v123
    buffer_store_short v120, v248, s[24:27], s45 offen offset:0
    buffer_store_short_d16_hi v120, v248, s[24:27], s45 offen offset:1024
    buffer_store_short v122, v248, s[24:27], s45 offen offset:2048
    buffer_store_short_d16_hi v122, v248, s[24:27], s45 offen offset:3072
    s_waitcnt lgkmcnt(0)
    s_nop 0
    v_pk_add_f32 v[100:101], v[100:101], v[108:109]
    v_pk_add_f32 v[124:125], v[36:37], v[116:117]
    v_pk_add_f32 v[102:103], v[102:103], v[110:111]
    v_pk_add_f32 v[126:127], v[38:39], v[118:119]
    v_pk_add_f32 v[124:125], v[124:125], v[100:101]
    v_pk_add_f32 v[126:127], v[126:127], v[102:103]
    v_cvt_pk_bf16_f32 v124, v124, v125
    v_cvt_pk_bf16_f32 v126, v126, v127
    buffer_store_short v124, v248, s[24:27], s46 offen offset:0
    buffer_store_short_d16_hi v124, v248, s[24:27], s46 offen offset:1024
    buffer_store_short v126, v248, s[24:27], s46 offen offset:2048
    buffer_store_short_d16_hi v126, v248, s[24:27], s46 offen offset:3072
L_exit:
    s_endpgm
L_end:
.section .rodata,"a"
.p2align 6
.amdhsa_kernel sequential_preLN__ssm_conv_s4__dense_activation_squared_relu__prompt_kernel
  .amdhsa_next_free_vgpr 512
  .amdhsa_next_free_sgpr 102
  .amdhsa_accum_offset 256
  .amdhsa_group_segment_fixed_size 0
  .amdhsa_kernarg_size 136
  .amdhsa_user_sgpr_count 2
  .amdhsa_user_sgpr_kernarg_segment_ptr 1
  .amdhsa_system_sgpr_workgroup_id_x 1
.end_amdhsa_kernel
```
